```python
import torch

def _softmax(x, axis=-1):
    return torch.softmax(x, dim=axis)
def _gelu(x):
    return torch.nn.functional.gelu(x, approximate="tanh")
def _silu(x):
    return torch.nn.functional.silu(x)
def _sigmoid(x):
    return torch.sigmoid(x)
def _layernorm(x, axis=-1, eps=1e-5):
    m = x.mean(dim=axis, keepdim=True)
    v = x.var(dim=axis, keepdim=True, unbiased=False)
    return (x - m) / torch.sqrt(v + eps)
def _scatter_add(tgt, idx, src, axis=0):
    return tgt.clone().index_add_(axis, idx, src)
def _segment_sum(src, seg, n):
    out = torch.zeros((n,) + src.shape[1:], dtype=src.dtype)
    return out.index_add_(0, seg, src)
def _pad(x, pw):
    flat = tuple(v for pair in reversed(pw) for v in pair)
    return torch.nn.functional.pad(x, flat)

kernel_name = 'parallel_sum__softmax_full_mha__dense_activation_squared_relu__prompt'

def setup_inputs():

    _w = (lambda a: (lambda t: t.to(torch.bfloat16) if t.is_floating_point() else t)(torch.as_tensor(a)))
    def _A_setup():
        B, S, D = 1, 2048, 448
        return {
            "x": _w((lambda *s: torch.randn(*s, dtype=torch.bfloat16) * 0.05)(B, S, D)),
            "wqkv": _w((lambda *s: torch.randn(*s, dtype=torch.bfloat16) * 0.2)(D, 3 * D)),
            "wo": _w((lambda *s: torch.randn(*s, dtype=torch.bfloat16) * 0.1)(D, D)),
        }
    _A_in = _A_setup()

    def _B_setup():
        B, S, D, F = 1, 2048, 448, 1792
        return {
            "x": _w((lambda *s: torch.randn(*s, dtype=torch.bfloat16) * 0.05)(B, S, D)),
            "w1": _w((lambda *s: torch.randn(*s, dtype=torch.bfloat16) * 0.1)(D, F)),
            "b1": _w((lambda *s: torch.randn(*s, dtype=torch.bfloat16) * 0.8)(F)),
            "w2": _w((lambda *s: torch.randn(*s, dtype=torch.bfloat16) * 0.1)(F, D)),
            "b2": _w((lambda *s: torch.randn(*s, dtype=torch.bfloat16) * 12.8)(D)),
        }
    _B_in = _B_setup()

    return {
        "A_x": _A_in["x"],
        "A_wqkv": _A_in["wqkv"],
        "A_wo": _A_in["wo"],
        "B_x": _B_in["x"],
        "B_w1": _B_in["w1"],
        "B_b1": _B_in["b1"],
        "B_w2": _B_in["w2"],
        "B_b2": _B_in["b2"],
    }

def reference(A_x, A_wqkv, A_wo, B_x, B_w1, B_b1, B_w2, B_b2):
    def _A_ref(x, wqkv, wo):
        B, S, D = x.shape
        H = 16; Dh = D // H
        qkv = (lambda x, *d: x.permute(*d))((x @ wqkv).reshape(B, S, 3, H, Dh), 2, 0, 3, 1, 4)
        q, k, v = qkv[0], qkv[1], qkv[2]
        scale = Dh ** -0.5
        scores = torch.einsum("bhqd,bhkd->bhqk", q, k) * scale
        p = _softmax(scores, axis=-1)
        o = torch.einsum("bhqk,bhkd->bhqd", p, v)
        return (lambda x, *d: x.permute(*d))(o, 0, 2, 1, 3).reshape(B, S, D) @ wo

    def _B_ref(x, w1, b1, w2, b2):
        h = torch.einsum("bsd,df->bsf", x, w1) + b1
        zero = torch.zeros_like(h)
        r = torch.where(h > zero, h, zero)
        h = r * r
        out = torch.einsum("bsf,fd->bsd", h, w2) + b2
        return out

    x = A_x
    xn = _layernorm(x, axis=-1)
    return x + _A_ref(xn, A_wqkv, A_wo) + _B_ref(xn, B_w1, B_b1, B_w2, B_b2)
```

```asm
; @launch grid=(256,1,1) block=(512,1,1) lds=163840
.amdgcn_target "amdgcn-amd-amdhsa--gfx950"
.text
.globl parallel_sum__softmax_full_mha__dense_activation_squared_relu__prompt_kernel
.p2align 8
.type parallel_sum__softmax_full_mha__dense_activation_squared_relu__prompt_kernel,@function
parallel_sum__softmax_full_mha__dense_activation_squared_relu__prompt_kernel:
  s_cmp_ge_u32 s2, 256
  s_cbranch_scc1 L_end
  s_getpc_b64 s[98:99]
  s_load_dwordx16 s[64:79], s[0:1], 0
  s_load_dwordx4 s[80:83], s[0:1], 64
  s_load_dwordx2 s[84:85], s[0:1], 80
  v_and_b32 v1, 63, v0
  v_lshrrev_b32 v2, 6, v0
  s_and_b32 s44, s2, 7
  s_lshr_b32 s45, s2, 3
  v_readfirstlane_b32 s26, v2
  s_nop 0
  s_cmp_lg_u32 s26, 7
  s_cbranch_scc1 L_pfc_1
  s_lshl_b32 s46, s45, 10
  v_lshlrev_b32 v3, 4, v1
  v_add_u32 v3, s46, v3
  v_min_u32 v3, 0x7d00, v3
  global_load_dwordx4 v[240:243], v3, s[98:99]
L_pfc_1:
  s_lshr_b32 s46, s44, 1
  s_lshl_b32 s46, s46, 2
  s_and_b32 s47, s45, 3
  s_add_u32 s24, s46, s47
  s_and_b32 s46, s44, 1
  s_lshl_b32 s46, s46, 3
  s_lshr_b32 s47, s45, 2
  s_add_u32 s25, s46, s47
  s_lshl_b32 s32, s44, 1
  s_lshr_b32 s46, s45, 4
  s_add_u32 s32, s32, s46
  s_and_b32 s33, s45, 15
  s_lshr_b32 s34, s26, 2
  s_and_b32 s35, s26, 3
  s_lshl_b32 s36, s44, 2
  s_and_b32 s46, s45, 3
  s_add_u32 s36, s36, s46
  s_lshr_b32 s37, s45, 2
  s_and_b32 s38, s26, 1
  s_lshr_b32 s39, s26, 1
  s_mov_b32 s40, 0x3f803f80
  s_mov_b32 s41, 0xffff0000
  s_mov_b32 s42, 0
  s_mov_b32 s43, -1
  s_mov_b32 s61, 0
  s_cmp_eq_u32 s34, 1
  s_cselect_b32 s31, -1, 0
  s_mov_b32 s30, 0
  s_cmp_ge_u32 s26, 4
  s_cbranch_scc1 L_helper
  v_lshrrev_b32 v233, 4, v1
  v_and_b32 v234, 7, v1
  v_xor_b32 v233, v233, v234
  v_lshlrev_b32 v233, 4, v233
  v_lshrrev_b32 v234, 3, v1
  v_mul_u32_u24 v234, 896, v234
  v_add_u32 v9, v233, v234
  v_add_u32 v11, 14336, v9
  v_lshrrev_b32 v233, 4, v1
  v_add_u32 v233, 4, v233
  v_and_b32 v234, 7, v1
  v_xor_b32 v233, v233, v234
  v_lshlrev_b32 v233, 4, v233
  v_lshrrev_b32 v234, 3, v1
  v_mul_u32_u24 v234, 896, v234
  v_add_u32 v233, 7168, v233
  v_add_u32 v10, v233, v234
  v_add_u32 v12, 14336, v10
  s_lshl_b32 s44, s24, 2
  s_add_u32 s44, s44, s26
  s_mul_i32 s44, s44, 28672
  s_lshl_b32 s46, s26, 12
  s_waitcnt lgkmcnt(0)
  s_mov_b32 s4, s64
  s_and_b32 s5, s65, 0xffff
  s_mov_b32 s6, 0x1c0000
  s_mov_b32 s7, 0x00020000
  s_mul_i32 s56, s24, 114688
  s_and_b32 s57, s25, 7
  s_mul_i32 s57, s57, 14336
  s_add_u32 s56, s56, s57
  s_mul_i32 s57, s26, 3584
  s_add_u32 s56, s56, s57
  v_lshlrev_b32 v235, 4, v1
  buffer_load_dwordx4 v[128:131], v235, s[4:7], s56 offen offset:0
  buffer_load_dwordx4 v[128:131], v235, s[4:7], s56 offen offset:1024
  buffer_load_dwordx4 v[128:131], v235, s[4:7], s56 offen offset:2048
  buffer_load_dwordx4 v[128:131], v235, s[4:7], s56 offen offset:2560
  s_mov_b32 s16, s84
  s_and_b32 s17, s85, 0xffff
  s_mov_b32 s18, 0x10000000
  s_mov_b32 s19, 0x00020000
  v_and_b32 v233, 31, v1
  v_lshlrev_b32 v234, 7, v233
  v_add_u32 v234, s46, v234
  v_bfe_u32 v233, v1, 1, 3
  v_lshrrev_b32 v235, 5, v1
  v_xor_b32 v233, v233, v235
  v_xor_b32 v235, 0, v233
  v_lshlrev_b32 v235, 4, v235
  v_add_u32 v2, v234, v235
  v_xor_b32 v235, 2, v233
  v_lshlrev_b32 v235, 4, v235
  v_add_u32 v3, v234, v235
  v_xor_b32 v235, 4, v233
  v_lshlrev_b32 v235, 4, v235
  v_add_u32 v4, v234, v235
  v_xor_b32 v235, 6, v233
  v_lshlrev_b32 v235, 4, v235
  v_add_u32 v5, v234, v235
  v_lshlrev_b32 v237, 4, v1
  v_lshrrev_b32 v238, 6, v237
  v_mul_u32_u24 v238, 43, v238
  v_lshrrev_b32 v238, 7, v238
  v_mul_u32_u24 v239, 192, v238
  v_sub_u32 v239, v237, v239
  v_mul_u32_u24 v238, 2688, v238
  v_add_u32 v196, v238, v239
  v_lshlrev_b32 v237, 4, v1
  v_add_u32 v237, 1024, v237
  v_lshrrev_b32 v238, 6, v237
  v_mul_u32_u24 v238, 43, v238
  v_lshrrev_b32 v238, 7, v238
  v_mul_u32_u24 v239, 192, v238
  v_sub_u32 v239, v237, v239
  v_mul_u32_u24 v238, 2688, v238
  v_add_u32 v197, v238, v239
  v_lshlrev_b32 v237, 4, v1
  v_add_u32 v237, 2048, v237
  v_lshrrev_b32 v238, 6, v237
  v_mul_u32_u24 v238, 43, v238
  v_lshrrev_b32 v238, 7, v238
  v_mul_u32_u24 v239, 192, v238
  v_sub_u32 v239, v237, v239
  v_mul_u32_u24 v238, 2688, v238
  v_add_u32 v198, v238, v239
  s_mov_b32 s8, s66
  s_and_b32 s9, s67, 0xffff
  s_mov_b32 s10, 0x126000
  s_mov_b32 s11, 0x00020000
  s_mov_b32 s12, s72
  s_and_b32 s13, s73, 0xffff
  s_mov_b32 s14, 0x188000
  s_mov_b32 s15, 0x00020000
  s_mul_i32 s56, s26, 43008
  s_mul_i32 s57, s25, 168
  s_add_u32 s56, s56, s57
  s_and_b32 s57, s25, 1
  s_lshl_b32 s57, s57, 3
  s_sub_u32 s56, s56, s57
  s_mul_i32 s57, s26, 3072
  s_mul_i32 s58, s26, 28672
  s_lshl_b32 s59, s25, 8
  s_add_u32 s58, s58, s59
  s_lshl_b32 s59, s26, 10
  v_lshlrev_b32 v238, 4, v1
  v_lshrrev_b32 v240, 5, v1
  v_lshlrev_b32 v240, 4, v240
  v_add_u32 v239, 151552, v240
  v_lshrrev_b32 v206, 5, v1
  v_lshlrev_b32 v207, 2, v206
  v_and_b32 v241, 31, v1
  v_xor_b32 v207, v207, v241
  v_lshlrev_b32 v206, 9, v206
  v_add_u32 v206, 2048, v206
  v_lshlrev_b32 v241, 4, v207
  v_add_u32 v241, v241, v206
  v_xor_b32 v207, 8, v207
  v_lshlrev_b32 v207, 4, v207
  v_add_u32 v207, v207, v206
  v_add_u32 v207, 1024, v207
  v_add_u32 v206, 1024, v238
  s_lshl_b32 s47, s24, 2
  s_add_u32 s47, s47, s26
  s_mul_i32 s60, s25, 3
  s_add_u32 s60, s60, 0
  s_lshr_b32 s63, s60, 4
  s_and_b32 s60, s60, 15
  s_lshl_b32 s60, s60, 6
  s_add_u32 s60, s60, s47
  s_lshl_b32 s48, s60, 11
  s_lshl_b32 s60, s60, 12
  s_add_u32 s60, s60, 2097152
  s_cmp_eq_u32 s63, 0
  s_cselect_b32 s48, s48, s60
  s_cselect_b32 s51, 0x3e8b97f6, 1.0
  s_cmp_eq_u32 s63, 2
  s_cselect_b64 vcc, -1, 0
  v_cndmask_b32 v200, v238, v241, vcc
  v_cndmask_b32 v201, v206, v207, vcc
  s_mul_i32 s60, s25, 3
  s_add_u32 s60, s60, 1
  s_lshr_b32 s63, s60, 4
  s_and_b32 s60, s60, 15
  s_lshl_b32 s60, s60, 6
  s_add_u32 s60, s60, s47
  s_lshl_b32 s49, s60, 11
  s_lshl_b32 s60, s60, 12
  s_add_u32 s60, s60, 2097152
  s_cmp_eq_u32 s63, 0
  s_cselect_b32 s49, s49, s60
  s_cselect_b32 s52, 0x3e8b97f6, 1.0
  s_cmp_eq_u32 s63, 2
  s_cselect_b64 vcc, -1, 0
  v_cndmask_b32 v202, v238, v241, vcc
  v_cndmask_b32 v203, v206, v207, vcc
  s_mul_i32 s60, s25, 3
  s_add_u32 s60, s60, 2
  s_lshr_b32 s63, s60, 4
  s_and_b32 s60, s60, 15
  s_lshl_b32 s60, s60, 6
  s_add_u32 s60, s60, s47
  s_lshl_b32 s50, s60, 11
  s_lshl_b32 s60, s60, 12
  s_add_u32 s60, s60, 2097152
  s_cmp_eq_u32 s63, 0
  s_cselect_b32 s50, s50, s60
  s_cselect_b32 s53, 0x3e8b97f6, 1.0
  s_cmp_eq_u32 s63, 2
  s_cselect_b64 vcc, -1, 0
  v_cndmask_b32 v204, v238, v241, vcc
  v_cndmask_b32 v205, v206, v207, vcc
  s_mul_i32 s55, s47, 56
  s_lshl_b32 s60, s25, 2
  s_add_u32 s55, s55, s60
  s_lshl_b32 s55, s55, 11
  s_add_u32 s55, s55, 6291456
  v_lshrrev_b32 v233, 5, v1
  v_lshlrev_b32 v233, 3, v233
  v_bfe_u32 v234, v1, 2, 2
  v_add_u32 v233, v233, v234
  v_mul_u32_u24 v233, 192, v233
  v_bfe_u32 v234, v1, 4, 1
  v_lshlrev_b32 v234, 5, v234
  v_add_u32 v233, v233, v234
  v_and_b32 v234, 3, v1
  v_lshlrev_b32 v234, 3, v234
  v_add_u32 v233, v233, v234
  s_and_b32 s60, s25, 1
  s_lshl_b32 s60, s60, 3
  s_add_u32 s63, s60, 114688
  s_add_u32 s60, s60, 65536
  v_add_u32 v6, s63, v233
  v_add_u32 v7, s60, v233
  v_lshrrev_b32 v233, 5, v1
  v_mul_u32_u24 v233, 8, v233
  v_bfe_u32 v234, v1, 2, 2
  v_add_u32 v233, v233, v234
  v_lshlrev_b32 v237, 7, v233
  v_bfe_u32 v233, v1, 4, 1
  v_lshlrev_b32 v233, 5, v233
  v_and_b32 v234, 3, v1
  v_lshlrev_b32 v234, 3, v234
  v_add_u32 v233, v233, v234
  v_bfe_u32 v234, v1, 3, 1
  v_lshlrev_b32 v234, 6, v234
  v_xor_b32 v233, v233, v234
  v_add_u32 v237, v237, v233
  v_xor_b32 v241, 64, v237
  v_mov_b32 v13, 0
  v_mov_b32 v14, 0
  v_mov_b32 v15, 0
  v_mov_b32 v232, 0
  s_add_u32 m0, s46, 0
  s_add_u32 s45, s44, 0
  buffer_load_dwordx4 v9, s[4:7], s45 offen lds
  s_add_u32 m0, s46, 1024
  s_nop 0
  buffer_load_dwordx4 v10, s[4:7], s45 offen lds
  s_add_u32 m0, s46, 2048
  s_nop 0
  buffer_load_dwordx4 v11, s[4:7], s45 offen lds
  s_add_u32 m0, s46, 3072
  s_nop 0
  buffer_load_dwordx4 v12, s[4:7], s45 offen lds
  s_add_u32 m0, s46, 16384
  s_add_u32 s45, s44, 128
  buffer_load_dwordx4 v9, s[4:7], s45 offen lds
  s_add_u32 m0, s46, 17408
  s_nop 0
  buffer_load_dwordx4 v10, s[4:7], s45 offen lds
  s_add_u32 m0, s46, 18432
  s_nop 0
  buffer_load_dwordx4 v11, s[4:7], s45 offen lds
  s_add_u32 m0, s46, 19456
  s_nop 0
  buffer_load_dwordx4 v12, s[4:7], s45 offen lds
  s_add_u32 m0, s46, 32768
  s_add_u32 s45, s44, 256
  buffer_load_dwordx4 v9, s[4:7], s45 offen lds
  s_add_u32 m0, s46, 33792
  s_nop 0
  buffer_load_dwordx4 v10, s[4:7], s45 offen lds
  s_add_u32 m0, s46, 34816
  s_nop 0
  buffer_load_dwordx4 v11, s[4:7], s45 offen lds
  s_add_u32 m0, s46, 35840
  s_nop 0
  buffer_load_dwordx4 v12, s[4:7], s45 offen lds
  s_add_u32 m0, s46, 49152
  s_add_u32 s45, s44, 384
  buffer_load_dwordx4 v9, s[4:7], s45 offen lds
  s_add_u32 m0, s46, 50176
  s_nop 0
  buffer_load_dwordx4 v10, s[4:7], s45 offen lds
  s_add_u32 m0, s46, 51200
  s_nop 0
  buffer_load_dwordx4 v11, s[4:7], s45 offen lds
  s_add_u32 m0, s46, 52224
  s_nop 0
  buffer_load_dwordx4 v12, s[4:7], s45 offen lds
  s_add_u32 m0, s46, 65536
  s_add_u32 s45, s44, 512
  buffer_load_dwordx4 v9, s[4:7], s45 offen lds
  s_add_u32 m0, s46, 66560
  s_nop 0
  buffer_load_dwordx4 v10, s[4:7], s45 offen lds
  s_add_u32 m0, s46, 67584
  s_nop 0
  buffer_load_dwordx4 v11, s[4:7], s45 offen lds
  s_add_u32 m0, s46, 68608
  s_nop 0
  buffer_load_dwordx4 v12, s[4:7], s45 offen lds
  s_add_u32 m0, s46, 81920
  s_add_u32 s45, s44, 640
  buffer_load_dwordx4 v9, s[4:7], s45 offen lds
  s_add_u32 m0, s46, 82944
  s_nop 0
  buffer_load_dwordx4 v10, s[4:7], s45 offen lds
  s_add_u32 m0, s46, 83968
  s_nop 0
  buffer_load_dwordx4 v11, s[4:7], s45 offen lds
  s_add_u32 m0, s46, 84992
  s_nop 0
  buffer_load_dwordx4 v12, s[4:7], s45 offen lds
  s_add_u32 m0, s46, 98304
  s_add_u32 s45, s44, 768
  buffer_load_dwordx4 v9, s[4:7], s45 offen lds
  s_add_u32 m0, s46, 99328
  s_nop 0
  buffer_load_dwordx4 v10, s[4:7], s45 offen lds
  s_add_u32 m0, s46, 100352
  s_nop 0
  buffer_load_dwordx4 v11, s[4:7], s45 offen lds
  s_add_u32 m0, s46, 101376
  s_nop 0
  buffer_load_dwordx4 v12, s[4:7], s45 offen lds
  s_barrier
  s_waitcnt vmcnt(24)
  ds_read_b128 v[16:19], v2 offset:0
  ds_read_b128 v[20:23], v3 offset:0
  ds_read_b128 v[24:27], v4 offset:0
  ds_read_b128 v[28:31], v5 offset:0
  s_waitcnt vmcnt(20)
  ds_read_b128 v[32:35], v2 offset:16384
  ds_read_b128 v[36:39], v3 offset:16384
  ds_read_b128 v[40:43], v4 offset:16384
  ds_read_b128 v[44:47], v5 offset:16384
  s_waitcnt lgkmcnt(4)
  v_dot2c_f32_bf16 v13, s40, v16
  v_dot2c_f32_bf16 v15, v16, v16
  v_dot2c_f32_bf16 v14, s40, v17
  v_dot2c_f32_bf16 v232, v17, v17
  v_dot2c_f32_bf16 v13, s40, v18
  v_dot2c_f32_bf16 v15, v18, v18
  v_dot2c_f32_bf16 v14, s40, v19
  v_dot2c_f32_bf16 v232, v19, v19
  v_dot2c_f32_bf16 v13, s40, v20
  v_dot2c_f32_bf16 v15, v20, v20
  v_dot2c_f32_bf16 v14, s40, v21
  v_dot2c_f32_bf16 v232, v21, v21
  v_dot2c_f32_bf16 v13, s40, v22
  v_dot2c_f32_bf16 v15, v22, v22
  v_dot2c_f32_bf16 v14, s40, v23
  v_dot2c_f32_bf16 v232, v23, v23
  v_dot2c_f32_bf16 v13, s40, v24
  v_dot2c_f32_bf16 v15, v24, v24
  v_dot2c_f32_bf16 v14, s40, v25
  v_dot2c_f32_bf16 v232, v25, v25
  v_dot2c_f32_bf16 v13, s40, v26
  v_dot2c_f32_bf16 v15, v26, v26
  v_dot2c_f32_bf16 v14, s40, v27
  v_dot2c_f32_bf16 v232, v27, v27
  v_dot2c_f32_bf16 v13, s40, v28
  v_dot2c_f32_bf16 v15, v28, v28
  v_dot2c_f32_bf16 v14, s40, v29
  v_dot2c_f32_bf16 v232, v29, v29
  v_dot2c_f32_bf16 v13, s40, v30
  v_dot2c_f32_bf16 v15, v30, v30
  v_dot2c_f32_bf16 v14, s40, v31
  v_dot2c_f32_bf16 v232, v31, v31
  s_waitcnt vmcnt(16)
  ds_read_b128 v[48:51], v2 offset:32768
  ds_read_b128 v[52:55], v3 offset:32768
  ds_read_b128 v[56:59], v4 offset:32768
  ds_read_b128 v[60:63], v5 offset:32768
  s_waitcnt lgkmcnt(4)
  v_dot2c_f32_bf16 v13, s40, v32
  v_dot2c_f32_bf16 v15, v32, v32
  v_dot2c_f32_bf16 v14, s40, v33
  v_dot2c_f32_bf16 v232, v33, v33
  v_dot2c_f32_bf16 v13, s40, v34
  v_dot2c_f32_bf16 v15, v34, v34
  v_dot2c_f32_bf16 v14, s40, v35
  v_dot2c_f32_bf16 v232, v35, v35
  v_dot2c_f32_bf16 v13, s40, v36
  v_dot2c_f32_bf16 v15, v36, v36
  v_dot2c_f32_bf16 v14, s40, v37
  v_dot2c_f32_bf16 v232, v37, v37
  v_dot2c_f32_bf16 v13, s40, v38
  v_dot2c_f32_bf16 v15, v38, v38
  v_dot2c_f32_bf16 v14, s40, v39
  v_dot2c_f32_bf16 v232, v39, v39
  v_dot2c_f32_bf16 v13, s40, v40
  v_dot2c_f32_bf16 v15, v40, v40
  v_dot2c_f32_bf16 v14, s40, v41
  v_dot2c_f32_bf16 v232, v41, v41
  v_dot2c_f32_bf16 v13, s40, v42
  v_dot2c_f32_bf16 v15, v42, v42
  v_dot2c_f32_bf16 v14, s40, v43
  v_dot2c_f32_bf16 v232, v43, v43
  v_dot2c_f32_bf16 v13, s40, v44
  v_dot2c_f32_bf16 v15, v44, v44
  v_dot2c_f32_bf16 v14, s40, v45
  v_dot2c_f32_bf16 v232, v45, v45
  v_dot2c_f32_bf16 v13, s40, v46
  v_dot2c_f32_bf16 v15, v46, v46
  v_dot2c_f32_bf16 v14, s40, v47
  v_dot2c_f32_bf16 v232, v47, v47
  s_waitcnt vmcnt(12)
  ds_read_b128 v[64:67], v2 offset:49152
  ds_read_b128 v[68:71], v3 offset:49152
  ds_read_b128 v[72:75], v4 offset:49152
  ds_read_b128 v[76:79], v5 offset:49152
  s_waitcnt lgkmcnt(4)
  v_dot2c_f32_bf16 v13, s40, v48
  v_dot2c_f32_bf16 v15, v48, v48
  v_dot2c_f32_bf16 v14, s40, v49
  v_dot2c_f32_bf16 v232, v49, v49
  v_dot2c_f32_bf16 v13, s40, v50
  v_dot2c_f32_bf16 v15, v50, v50
  v_dot2c_f32_bf16 v14, s40, v51
  v_dot2c_f32_bf16 v232, v51, v51
  v_dot2c_f32_bf16 v13, s40, v52
  v_dot2c_f32_bf16 v15, v52, v52
  v_dot2c_f32_bf16 v14, s40, v53
  v_dot2c_f32_bf16 v232, v53, v53
  v_dot2c_f32_bf16 v13, s40, v54
  v_dot2c_f32_bf16 v15, v54, v54
  v_dot2c_f32_bf16 v14, s40, v55
  v_dot2c_f32_bf16 v232, v55, v55
  v_dot2c_f32_bf16 v13, s40, v56
  v_dot2c_f32_bf16 v15, v56, v56
  v_dot2c_f32_bf16 v14, s40, v57
  v_dot2c_f32_bf16 v232, v57, v57
  v_dot2c_f32_bf16 v13, s40, v58
  v_dot2c_f32_bf16 v15, v58, v58
  v_dot2c_f32_bf16 v14, s40, v59
  v_dot2c_f32_bf16 v232, v59, v59
  v_dot2c_f32_bf16 v13, s40, v60
  v_dot2c_f32_bf16 v15, v60, v60
  v_dot2c_f32_bf16 v14, s40, v61
  v_dot2c_f32_bf16 v232, v61, v61
  v_dot2c_f32_bf16 v13, s40, v62
  v_dot2c_f32_bf16 v15, v62, v62
  v_dot2c_f32_bf16 v14, s40, v63
  v_dot2c_f32_bf16 v232, v63, v63
  s_waitcnt vmcnt(8)
  v_add_u32 v2, 0x10000, v2
  v_add_u32 v3, 0x10000, v3
  v_add_u32 v4, 0x10000, v4
  v_add_u32 v5, 0x10000, v5
  ds_read_b128 v[80:83], v2 offset:0
  ds_read_b128 v[84:87], v3 offset:0
  ds_read_b128 v[88:91], v4 offset:0
  ds_read_b128 v[92:95], v5 offset:0
  s_waitcnt lgkmcnt(4)
  v_dot2c_f32_bf16 v13, s40, v64
  v_dot2c_f32_bf16 v15, v64, v64
  v_dot2c_f32_bf16 v14, s40, v65
  v_dot2c_f32_bf16 v232, v65, v65
  v_dot2c_f32_bf16 v13, s40, v66
  v_dot2c_f32_bf16 v15, v66, v66
  v_dot2c_f32_bf16 v14, s40, v67
  v_dot2c_f32_bf16 v232, v67, v67
  v_dot2c_f32_bf16 v13, s40, v68
  v_dot2c_f32_bf16 v15, v68, v68
  v_dot2c_f32_bf16 v14, s40, v69
  v_dot2c_f32_bf16 v232, v69, v69
  v_dot2c_f32_bf16 v13, s40, v70
  v_dot2c_f32_bf16 v15, v70, v70
  v_dot2c_f32_bf16 v14, s40, v71
  v_dot2c_f32_bf16 v232, v71, v71
  v_dot2c_f32_bf16 v13, s40, v72
  v_dot2c_f32_bf16 v15, v72, v72
  v_dot2c_f32_bf16 v14, s40, v73
  v_dot2c_f32_bf16 v232, v73, v73
  v_dot2c_f32_bf16 v13, s40, v74
  v_dot2c_f32_bf16 v15, v74, v74
  v_dot2c_f32_bf16 v14, s40, v75
  v_dot2c_f32_bf16 v232, v75, v75
  v_dot2c_f32_bf16 v13, s40, v76
  v_dot2c_f32_bf16 v15, v76, v76
  v_dot2c_f32_bf16 v14, s40, v77
  v_dot2c_f32_bf16 v232, v77, v77
  v_dot2c_f32_bf16 v13, s40, v78
  v_dot2c_f32_bf16 v15, v78, v78
  v_dot2c_f32_bf16 v14, s40, v79
  v_dot2c_f32_bf16 v232, v79, v79
  s_waitcnt vmcnt(4)
  ds_read_b128 v[96:99], v2 offset:16384
  ds_read_b128 v[100:103], v3 offset:16384
  ds_read_b128 v[104:107], v4 offset:16384
  ds_read_b128 v[108:111], v5 offset:16384
  s_waitcnt lgkmcnt(4)
  v_dot2c_f32_bf16 v13, s40, v80
  v_dot2c_f32_bf16 v15, v80, v80
  v_dot2c_f32_bf16 v14, s40, v81
  v_dot2c_f32_bf16 v232, v81, v81
  v_dot2c_f32_bf16 v13, s40, v82
  v_dot2c_f32_bf16 v15, v82, v82
  v_dot2c_f32_bf16 v14, s40, v83
  v_dot2c_f32_bf16 v232, v83, v83
  v_dot2c_f32_bf16 v13, s40, v84
  v_dot2c_f32_bf16 v15, v84, v84
  v_dot2c_f32_bf16 v14, s40, v85
  v_dot2c_f32_bf16 v232, v85, v85
  v_dot2c_f32_bf16 v13, s40, v86
  v_dot2c_f32_bf16 v15, v86, v86
  v_dot2c_f32_bf16 v14, s40, v87
  v_dot2c_f32_bf16 v232, v87, v87
  v_dot2c_f32_bf16 v13, s40, v88
  v_dot2c_f32_bf16 v15, v88, v88
  v_dot2c_f32_bf16 v14, s40, v89
  v_dot2c_f32_bf16 v232, v89, v89
  v_dot2c_f32_bf16 v13, s40, v90
  v_dot2c_f32_bf16 v15, v90, v90
  v_dot2c_f32_bf16 v14, s40, v91
  v_dot2c_f32_bf16 v232, v91, v91
  v_dot2c_f32_bf16 v13, s40, v92
  v_dot2c_f32_bf16 v15, v92, v92
  v_dot2c_f32_bf16 v14, s40, v93
  v_dot2c_f32_bf16 v232, v93, v93
  v_dot2c_f32_bf16 v13, s40, v94
  v_dot2c_f32_bf16 v15, v94, v94
  v_dot2c_f32_bf16 v14, s40, v95
  v_dot2c_f32_bf16 v232, v95, v95
  s_waitcnt vmcnt(0)
  ds_read_b128 v[112:115], v2 offset:32768
  ds_read_b128 v[116:119], v3 offset:32768
  ds_read_b128 v[120:123], v4 offset:32768
  ds_read_b128 v[124:127], v5 offset:32768
  s_waitcnt lgkmcnt(4)
  v_dot2c_f32_bf16 v13, s40, v96
  v_dot2c_f32_bf16 v15, v96, v96
  v_dot2c_f32_bf16 v14, s40, v97
  v_dot2c_f32_bf16 v232, v97, v97
  v_dot2c_f32_bf16 v13, s40, v98
  v_dot2c_f32_bf16 v15, v98, v98
  v_dot2c_f32_bf16 v14, s40, v99
  v_dot2c_f32_bf16 v232, v99, v99
  v_dot2c_f32_bf16 v13, s40, v100
  v_dot2c_f32_bf16 v15, v100, v100
  v_dot2c_f32_bf16 v14, s40, v101
  v_dot2c_f32_bf16 v232, v101, v101
  v_dot2c_f32_bf16 v13, s40, v102
  v_dot2c_f32_bf16 v15, v102, v102
  v_dot2c_f32_bf16 v14, s40, v103
  v_dot2c_f32_bf16 v232, v103, v103
  v_dot2c_f32_bf16 v13, s40, v104
  v_dot2c_f32_bf16 v15, v104, v104
  v_dot2c_f32_bf16 v14, s40, v105
  v_dot2c_f32_bf16 v232, v105, v105
  v_dot2c_f32_bf16 v13, s40, v106
  v_dot2c_f32_bf16 v15, v106, v106
  v_dot2c_f32_bf16 v14, s40, v107
  v_dot2c_f32_bf16 v232, v107, v107
  v_dot2c_f32_bf16 v13, s40, v108
  v_dot2c_f32_bf16 v15, v108, v108
  v_dot2c_f32_bf16 v14, s40, v109
  v_dot2c_f32_bf16 v232, v109, v109
  v_dot2c_f32_bf16 v13, s40, v110
  v_dot2c_f32_bf16 v15, v110, v110
  v_dot2c_f32_bf16 v14, s40, v111
  v_dot2c_f32_bf16 v232, v111, v111
  s_waitcnt lgkmcnt(0)
  v_dot2c_f32_bf16 v13, s40, v112
  v_dot2c_f32_bf16 v15, v112, v112
  v_dot2c_f32_bf16 v14, s40, v113
  v_dot2c_f32_bf16 v232, v113, v113
  v_dot2c_f32_bf16 v13, s40, v114
  v_dot2c_f32_bf16 v15, v114, v114
  v_dot2c_f32_bf16 v14, s40, v115
  v_dot2c_f32_bf16 v232, v115, v115
  v_dot2c_f32_bf16 v13, s40, v116
  v_dot2c_f32_bf16 v15, v116, v116
  v_dot2c_f32_bf16 v14, s40, v117
  v_dot2c_f32_bf16 v232, v117, v117
  v_dot2c_f32_bf16 v13, s40, v118
  v_dot2c_f32_bf16 v15, v118, v118
  v_dot2c_f32_bf16 v14, s40, v119
  v_dot2c_f32_bf16 v232, v119, v119
  v_dot2c_f32_bf16 v13, s40, v120
  v_dot2c_f32_bf16 v15, v120, v120
  v_dot2c_f32_bf16 v14, s40, v121
  v_dot2c_f32_bf16 v232, v121, v121
  v_dot2c_f32_bf16 v13, s40, v122
  v_dot2c_f32_bf16 v15, v122, v122
  v_dot2c_f32_bf16 v14, s40, v123
  v_dot2c_f32_bf16 v232, v123, v123
  v_dot2c_f32_bf16 v13, s40, v124
  v_dot2c_f32_bf16 v15, v124, v124
  v_dot2c_f32_bf16 v14, s40, v125
  v_dot2c_f32_bf16 v232, v125, v125
  v_dot2c_f32_bf16 v13, s40, v126
  v_dot2c_f32_bf16 v15, v126, v126
  v_dot2c_f32_bf16 v14, s40, v127
  v_dot2c_f32_bf16 v232, v127, v127
  s_nop 2
  v_add_f32 v13, v13, v14
  v_add_f32 v15, v15, v232
  v_mov_b32 v233, v13
  v_mov_b32 v234, v13
  s_nop 1
  v_permlane32_swap_b32 v233, v234
  v_add_f32 v13, v233, v234
  v_mov_b32 v233, v15
  v_mov_b32 v234, v15
  s_nop 1
  v_permlane32_swap_b32 v233, v234
  v_add_f32 v15, v233, v234
  v_mul_f32 v13, 0x3b124925, v13
  v_mul_f32 v15, 0x3b124925, v15
  v_fma_f32 v15, -v13, v13, v15
  v_max_f32 v15, 0, v15
  v_cvt_pk_bf16_f32 v233, v13, v13
  v_lshlrev_b32 v13, 16, v233
  v_cvt_pk_bf16_f32 v233, v15, v15
  v_lshlrev_b32 v15, 16, v233
  v_sub_f32 v10, 0, v13
  v_add_f32 v15, 0x3727c5ac, v15
  v_cvt_pk_bf16_f32 v233, v15, v15
  v_lshlrev_b32 v15, 16, v233
  v_sqrt_f32 v15, v15
  s_nop 0
  v_cvt_pk_bf16_f32 v233, v15, v15
  v_lshlrev_b32 v15, 16, v233
  v_rcp_f32 v236, v15
  v_cvt_pk_bf16_f32 v244, v10, v10
  v_mov_b32 v245, 0
  v_mov_b32 v246, 0
  v_mov_b32 v247, 0
  s_mov_b64 exec, s[42:43]
  v_mov_b32 v244, 0
  s_mov_b64 exec, -1
  v_mov_b32 v249, 0
  v_mov_b32 v250, 0
  v_mov_b32 v251, 0
  v_lshlrev_b32 v242, 2, v1
  v_add_u32 v242, 152064, v242
  s_barrier
  ds_read_b64_tr_b16 v[208:209], v6 offset:0
  ds_read_b64_tr_b16 v[210:211], v6 offset:768
  ds_read_b64_tr_b16 v[212:213], v6 offset:56
  ds_read_b64_tr_b16 v[214:215], v6 offset:824
  ds_read_b64_tr_b16 v[216:217], v6 offset:112
  ds_read_b64_tr_b16 v[218:219], v6 offset:880
  s_waitcnt lgkmcnt(4)
  v_mfma_f32_32x32x16_bf16 v[128:143], v[208:211], v[16:19], 0
  ds_read_b64_tr_b16 v[220:221], v6 offset:3072
  ds_read_b64_tr_b16 v[222:223], v6 offset:3840
  s_add_u32 m0, s57, 65536
  s_waitcnt lgkmcnt(4)
  v_mfma_f32_32x32x16_bf16 v[144:159], v[212:215], v[16:19], 0
  ds_read_b64_tr_b16 v[224:225], v6 offset:3128
  ds_read_b64_tr_b16 v[226:227], v6 offset:3896
  s_add_u32 s63, s56, 516096
  s_waitcnt lgkmcnt(4)
  v_mfma_f32_32x32x16_bf16 v[160:175], v[216:219], v[16:19], 0
  ds_read_b64_tr_b16 v[228:229], v6 offset:3184
  ds_read_b64_tr_b16 v[230:231], v6 offset:3952
  buffer_load_dwordx4 v196, s[8:11], s63 offen lds
  s_waitcnt lgkmcnt(4)
  v_mfma_f32_32x32x16_bf16 v[128:143], v[220:223], v[20:23], v[128:143]
  ds_read_b64_tr_b16 v[208:209], v6 offset:6144
  ds_read_b64_tr_b16 v[210:211], v6 offset:6912
  s_add_u32 m0, s57, 66560
  s_waitcnt lgkmcnt(4)
  v_mfma_f32_32x32x16_bf16 v[144:159], v[224:227], v[20:23], v[144:159]
  ds_read_b64_tr_b16 v[212:213], v6 offset:6200
  ds_read_b64_tr_b16 v[214:215], v6 offset:6968
  s_add_u32 s63, s56, 516096
  s_waitcnt lgkmcnt(4)
  v_mfma_f32_32x32x16_bf16 v[160:175], v[228:231], v[20:23], v[160:175]
  ds_read_b64_tr_b16 v[216:217], v6 offset:6256
  ds_read_b64_tr_b16 v[218:219], v6 offset:7024
  buffer_load_dwordx4 v197, s[8:11], s63 offen lds
  s_waitcnt lgkmcnt(4)
  v_mfma_f32_32x32x16_bf16 v[128:143], v[208:211], v[24:27], v[128:143]
  ds_read_b64_tr_b16 v[220:221], v6 offset:9216
  ds_read_b64_tr_b16 v[222:223], v6 offset:9984
  s_add_u32 m0, s57, 67584
  s_waitcnt lgkmcnt(4)
  v_mfma_f32_32x32x16_bf16 v[144:159], v[212:215], v[24:27], v[144:159]
  ds_read_b64_tr_b16 v[224:225], v6 offset:9272
  ds_read_b64_tr_b16 v[226:227], v6 offset:10040
  s_add_u32 s63, s56, 516096
  s_waitcnt lgkmcnt(4)
  v_mfma_f32_32x32x16_bf16 v[160:175], v[216:219], v[24:27], v[160:175]
  ds_read_b64_tr_b16 v[228:229], v6 offset:9328
  ds_read_b64_tr_b16 v[230:231], v6 offset:10096
  buffer_load_dwordx4 v198, s[8:11], s63 offen lds
  s_waitcnt lgkmcnt(4)
  v_mfma_f32_32x32x16_bf16 v[128:143], v[220:223], v[28:31], v[128:143]
  s_barrier
  ds_read_b64_tr_b16 v[208:209], v6 offset:12288
  ds_read_b64_tr_b16 v[210:211], v6 offset:13056
  s_add_u32 m0, s57, 77824
  s_waitcnt lgkmcnt(4)
  v_mfma_f32_32x32x16_bf16 v[144:159], v[224:227], v[28:31], v[144:159]
  ds_read_b64_tr_b16 v[212:213], v6 offset:12344
  ds_read_b64_tr_b16 v[214:215], v6 offset:13112
  s_add_u32 s63, s56, 688128
  s_waitcnt lgkmcnt(4)
  v_mfma_f32_32x32x16_bf16 v[160:175], v[228:231], v[28:31], v[160:175]
  ds_read_b64_tr_b16 v[216:217], v6 offset:12400
  ds_read_b64_tr_b16 v[218:219], v6 offset:13168
  buffer_load_dwordx4 v196, s[8:11], s63 offen lds
  s_waitcnt lgkmcnt(4)
  v_mfma_f32_32x32x16_bf16 v[128:143], v[208:211], v[32:35], v[128:143]
  ds_read_b64_tr_b16 v[220:221], v6 offset:15360
  ds_read_b64_tr_b16 v[222:223], v6 offset:16128
  s_add_u32 m0, s57, 78848
  s_waitcnt lgkmcnt(4)
  v_mfma_f32_32x32x16_bf16 v[144:159], v[212:215], v[32:35], v[144:159]
  ds_read_b64_tr_b16 v[224:225], v6 offset:15416
  ds_read_b64_tr_b16 v[226:227], v6 offset:16184
  s_add_u32 s63, s56, 688128
  s_waitcnt lgkmcnt(4)
  v_mfma_f32_32x32x16_bf16 v[160:175], v[216:219], v[32:35], v[160:175]
  ds_read_b64_tr_b16 v[228:229], v6 offset:15472
  ds_read_b64_tr_b16 v[230:231], v6 offset:16240
  buffer_load_dwordx4 v197, s[8:11], s63 offen lds
  s_waitcnt lgkmcnt(4)
  v_mfma_f32_32x32x16_bf16 v[128:143], v[220:223], v[36:39], v[128:143]
  ds_read_b64_tr_b16 v[208:209], v6 offset:18432
  ds_read_b64_tr_b16 v[210:211], v6 offset:19200
  s_add_u32 m0, s57, 79872
  s_waitcnt lgkmcnt(4)
  v_mfma_f32_32x32x16_bf16 v[144:159], v[224:227], v[36:39], v[144:159]
  ds_read_b64_tr_b16 v[212:213], v6 offset:18488
  ds_read_b64_tr_b16 v[214:215], v6 offset:19256
  s_add_u32 s63, s56, 688128
  s_waitcnt lgkmcnt(4)
  v_mfma_f32_32x32x16_bf16 v[160:175], v[228:231], v[36:39], v[160:175]
  ds_read_b64_tr_b16 v[216:217], v6 offset:18544
  ds_read_b64_tr_b16 v[218:219], v6 offset:19312
  buffer_load_dwordx4 v198, s[8:11], s63 offen lds
  s_waitcnt lgkmcnt(4)
  v_mfma_f32_32x32x16_bf16 v[128:143], v[208:211], v[40:43], v[128:143]
  ds_read_b64_tr_b16 v[220:221], v6 offset:21504
  ds_read_b64_tr_b16 v[222:223], v6 offset:22272
  s_add_u32 m0, s57, 90112
  s_waitcnt lgkmcnt(4)
  v_mfma_f32_32x32x16_bf16 v[144:159], v[212:215], v[40:43], v[144:159]
  ds_read_b64_tr_b16 v[224:225], v6 offset:21560
  ds_read_b64_tr_b16 v[226:227], v6 offset:22328
  s_add_u32 s63, s56, 860160
  s_waitcnt lgkmcnt(4)
  v_mfma_f32_32x32x16_bf16 v[160:175], v[216:219], v[40:43], v[160:175]
  ds_read_b64_tr_b16 v[228:229], v6 offset:21616
  ds_read_b64_tr_b16 v[230:231], v6 offset:22384
  buffer_load_dwordx4 v196, s[8:11], s63 offen lds
  s_waitcnt lgkmcnt(4)
  v_mfma_f32_32x32x16_bf16 v[128:143], v[220:223], v[44:47], v[128:143]
  s_barrier
  ds_read_b64_tr_b16 v[208:209], v6 offset:24576
  ds_read_b64_tr_b16 v[210:211], v6 offset:25344
  s_add_u32 m0, s57, 91136
  s_waitcnt lgkmcnt(4)
  v_mfma_f32_32x32x16_bf16 v[144:159], v[224:227], v[44:47], v[144:159]
  ds_read_b64_tr_b16 v[212:213], v6 offset:24632
  ds_read_b64_tr_b16 v[214:215], v6 offset:25400
  s_add_u32 s63, s56, 860160
  s_waitcnt lgkmcnt(4)
  v_mfma_f32_32x32x16_bf16 v[160:175], v[228:231], v[44:47], v[160:175]
  ds_read_b64_tr_b16 v[216:217], v6 offset:24688
  ds_read_b64_tr_b16 v[218:219], v6 offset:25456
  buffer_load_dwordx4 v197, s[8:11], s63 offen lds
  s_waitcnt lgkmcnt(4)
  v_mfma_f32_32x32x16_bf16 v[128:143], v[208:211], v[48:51], v[128:143]
  ds_read_b64_tr_b16 v[220:221], v6 offset:27648
  ds_read_b64_tr_b16 v[222:223], v6 offset:28416
  s_add_u32 m0, s57, 92160
  s_waitcnt lgkmcnt(4)
  v_mfma_f32_32x32x16_bf16 v[144:159], v[212:215], v[48:51], v[144:159]
  ds_read_b64_tr_b16 v[224:225], v6 offset:27704
  ds_read_b64_tr_b16 v[226:227], v6 offset:28472
  s_add_u32 s63, s56, 860160
  s_waitcnt lgkmcnt(4)
  v_mfma_f32_32x32x16_bf16 v[160:175], v[216:219], v[48:51], v[160:175]
  ds_read_b64_tr_b16 v[228:229], v6 offset:27760
  ds_read_b64_tr_b16 v[230:231], v6 offset:28528
  buffer_load_dwordx4 v198, s[8:11], s63 offen lds
  s_waitcnt lgkmcnt(4)
  v_mfma_f32_32x32x16_bf16 v[128:143], v[220:223], v[52:55], v[128:143]
  ds_read_b64_tr_b16 v[208:209], v6 offset:30720
  ds_read_b64_tr_b16 v[210:211], v6 offset:31488
  s_add_u32 m0, s57, 102400
  s_waitcnt lgkmcnt(4)
  v_mfma_f32_32x32x16_bf16 v[144:159], v[224:227], v[52:55], v[144:159]
  ds_read_b64_tr_b16 v[212:213], v6 offset:30776
  ds_read_b64_tr_b16 v[214:215], v6 offset:31544
  s_add_u32 s63, s56, 1032192
  s_waitcnt lgkmcnt(4)
  v_mfma_f32_32x32x16_bf16 v[160:175], v[228:231], v[52:55], v[160:175]
  ds_read_b64_tr_b16 v[216:217], v6 offset:30832
  ds_read_b64_tr_b16 v[218:219], v6 offset:31600
  buffer_load_dwordx4 v196, s[8:11], s63 offen lds
  s_waitcnt lgkmcnt(4)
  v_mfma_f32_32x32x16_bf16 v[128:143], v[208:211], v[56:59], v[128:143]
  ds_read_b64_tr_b16 v[220:221], v6 offset:33792
  ds_read_b64_tr_b16 v[222:223], v6 offset:34560
  s_add_u32 m0, s57, 103424
  s_waitcnt lgkmcnt(4)
  v_mfma_f32_32x32x16_bf16 v[144:159], v[212:215], v[56:59], v[144:159]
  ds_read_b64_tr_b16 v[224:225], v6 offset:33848
  ds_read_b64_tr_b16 v[226:227], v6 offset:34616
  s_add_u32 s63, s56, 1032192
  s_waitcnt lgkmcnt(4)
  v_mfma_f32_32x32x16_bf16 v[160:175], v[216:219], v[56:59], v[160:175]
  ds_read_b64_tr_b16 v[228:229], v6 offset:33904
  ds_read_b64_tr_b16 v[230:231], v6 offset:34672
  buffer_load_dwordx4 v197, s[8:11], s63 offen lds
  s_waitcnt lgkmcnt(4)
  v_mfma_f32_32x32x16_bf16 v[128:143], v[220:223], v[60:63], v[128:143]
  s_waitcnt vmcnt(8)
  s_barrier
  ds_read_b64_tr_b16 v[208:209], v7 offset:0
  ds_read_b64_tr_b16 v[210:211], v7 offset:768
  s_add_u32 m0, s57, 104448
  s_waitcnt lgkmcnt(4)
  v_mfma_f32_32x32x16_bf16 v[144:159], v[224:227], v[60:63], v[144:159]
  ds_read_b64_tr_b16 v[212:213], v7 offset:56
  ds_read_b64_tr_b16 v[214:215], v7 offset:824
  s_add_u32 s63, s56, 1032192
  s_waitcnt lgkmcnt(4)
  v_mfma_f32_32x32x16_bf16 v[160:175], v[228:231], v[60:63], v[160:175]
  ds_read_b64_tr_b16 v[216:217], v7 offset:112
  ds_read_b64_tr_b16 v[218:219], v7 offset:880
  buffer_load_dwordx4 v198, s[8:11], s63 offen lds
  s_waitcnt lgkmcnt(4)
  v_mfma_f32_32x32x16_bf16 v[128:143], v[208:211], v[64:67], v[128:143]
  ds_read_b64_tr_b16 v[220:221], v7 offset:3072
  ds_read_b64_tr_b16 v[222:223], v7 offset:3840
  s_waitcnt lgkmcnt(4)
  v_mfma_f32_32x32x16_bf16 v[144:159], v[212:215], v[64:67], v[144:159]
  ds_read_b64_tr_b16 v[224:225], v7 offset:3128
  ds_read_b64_tr_b16 v[226:227], v7 offset:3896
  s_waitcnt lgkmcnt(4)
  v_mfma_f32_32x32x16_bf16 v[160:175], v[216:219], v[64:67], v[160:175]
  ds_read_b64_tr_b16 v[228:229], v7 offset:3184
  ds_read_b64_tr_b16 v[230:231], v7 offset:3952
  s_waitcnt lgkmcnt(4)
  v_mfma_f32_32x32x16_bf16 v[128:143], v[220:223], v[68:71], v[128:143]
  ds_read_b64_tr_b16 v[208:209], v7 offset:6144
  ds_read_b64_tr_b16 v[210:211], v7 offset:6912
  s_waitcnt lgkmcnt(4)
  v_mfma_f32_32x32x16_bf16 v[144:159], v[224:227], v[68:71], v[144:159]
  ds_read_b64_tr_b16 v[212:213], v7 offset:6200
  ds_read_b64_tr_b16 v[214:215], v7 offset:6968
  s_waitcnt lgkmcnt(4)
  v_mfma_f32_32x32x16_bf16 v[160:175], v[228:231], v[68:71], v[160:175]
  ds_read_b64_tr_b16 v[216:217], v7 offset:6256
  ds_read_b64_tr_b16 v[218:219], v7 offset:7024
  s_waitcnt lgkmcnt(4)
  v_mfma_f32_32x32x16_bf16 v[128:143], v[208:211], v[72:75], v[128:143]
  ds_read_b64_tr_b16 v[220:221], v7 offset:9216
  ds_read_b64_tr_b16 v[222:223], v7 offset:9984
  s_waitcnt lgkmcnt(4)
  v_mfma_f32_32x32x16_bf16 v[144:159], v[212:215], v[72:75], v[144:159]
  ds_read_b64_tr_b16 v[224:225], v7 offset:9272
  ds_read_b64_tr_b16 v[226:227], v7 offset:10040
  s_waitcnt lgkmcnt(4)
  v_mfma_f32_32x32x16_bf16 v[160:175], v[216:219], v[72:75], v[160:175]
  ds_read_b64_tr_b16 v[228:229], v7 offset:9328
  ds_read_b64_tr_b16 v[230:231], v7 offset:10096
  s_waitcnt lgkmcnt(4)
  v_mfma_f32_32x32x16_bf16 v[128:143], v[220:223], v[76:79], v[128:143]
  s_waitcnt vmcnt(6)
  s_barrier
  ds_read_b64_tr_b16 v[208:209], v7 offset:12288
  ds_read_b64_tr_b16 v[210:211], v7 offset:13056
  s_waitcnt lgkmcnt(4)
  v_mfma_f32_32x32x16_bf16 v[144:159], v[224:227], v[76:79], v[144:159]
  ds_read_b64_tr_b16 v[212:213], v7 offset:12344
  ds_read_b64_tr_b16 v[214:215], v7 offset:13112
  s_waitcnt lgkmcnt(4)
  v_mfma_f32_32x32x16_bf16 v[160:175], v[228:231], v[76:79], v[160:175]
  ds_read_b64_tr_b16 v[216:217], v7 offset:12400
  ds_read_b64_tr_b16 v[218:219], v7 offset:13168
  s_waitcnt lgkmcnt(4)
  v_mfma_f32_32x32x16_bf16 v[128:143], v[208:211], v[80:83], v[128:143]
  ds_read_b64_tr_b16 v[220:221], v7 offset:15360
  ds_read_b64_tr_b16 v[222:223], v7 offset:16128
  s_waitcnt lgkmcnt(4)
  v_mfma_f32_32x32x16_bf16 v[144:159], v[212:215], v[80:83], v[144:159]
  ds_read_b64_tr_b16 v[224:225], v7 offset:15416
  ds_read_b64_tr_b16 v[226:227], v7 offset:16184
  s_waitcnt lgkmcnt(4)
  v_mfma_f32_32x32x16_bf16 v[160:175], v[216:219], v[80:83], v[160:175]
  ds_read_b64_tr_b16 v[228:229], v7 offset:15472
  ds_read_b64_tr_b16 v[230:231], v7 offset:16240
  s_waitcnt lgkmcnt(4)
  v_mfma_f32_32x32x16_bf16 v[128:143], v[220:223], v[84:87], v[128:143]
  ds_read_b64_tr_b16 v[208:209], v7 offset:18432
  ds_read_b64_tr_b16 v[210:211], v7 offset:19200
  s_waitcnt lgkmcnt(4)
  v_mfma_f32_32x32x16_bf16 v[144:159], v[224:227], v[84:87], v[144:159]
  ds_read_b64_tr_b16 v[212:213], v7 offset:18488
  ds_read_b64_tr_b16 v[214:215], v7 offset:19256
  s_waitcnt lgkmcnt(4)
  v_mfma_f32_32x32x16_bf16 v[160:175], v[228:231], v[84:87], v[160:175]
  ds_read_b64_tr_b16 v[216:217], v7 offset:18544
  ds_read_b64_tr_b16 v[218:219], v7 offset:19312
  s_waitcnt lgkmcnt(4)
  v_mfma_f32_32x32x16_bf16 v[128:143], v[208:211], v[88:91], v[128:143]
  ds_read_b64_tr_b16 v[220:221], v7 offset:21504
  ds_read_b64_tr_b16 v[222:223], v7 offset:22272
  s_waitcnt lgkmcnt(4)
  v_mfma_f32_32x32x16_bf16 v[144:159], v[212:215], v[88:91], v[144:159]
  ds_read_b64_tr_b16 v[224:225], v7 offset:21560
  ds_read_b64_tr_b16 v[226:227], v7 offset:22328
  s_waitcnt lgkmcnt(4)
  v_mfma_f32_32x32x16_bf16 v[160:175], v[216:219], v[88:91], v[160:175]
  ds_read_b64_tr_b16 v[228:229], v7 offset:21616
  ds_read_b64_tr_b16 v[230:231], v7 offset:22384
  s_waitcnt lgkmcnt(4)
  v_mfma_f32_32x32x16_bf16 v[128:143], v[220:223], v[92:95], v[128:143]
  s_waitcnt vmcnt(3)
  s_barrier
  ds_read_b64_tr_b16 v[208:209], v7 offset:24576
  ds_read_b64_tr_b16 v[210:211], v7 offset:25344
  s_waitcnt lgkmcnt(4)
  v_mfma_f32_32x32x16_bf16 v[144:159], v[224:227], v[92:95], v[144:159]
  ds_read_b64_tr_b16 v[212:213], v7 offset:24632
  ds_read_b64_tr_b16 v[214:215], v7 offset:25400
  s_waitcnt lgkmcnt(4)
  v_mfma_f32_32x32x16_bf16 v[160:175], v[228:231], v[92:95], v[160:175]
  ds_read_b64_tr_b16 v[216:217], v7 offset:24688
  ds_read_b64_tr_b16 v[218:219], v7 offset:25456
  s_waitcnt lgkmcnt(4)
  v_mfma_f32_32x32x16_bf16 v[128:143], v[208:211], v[96:99], v[128:143]
  ds_read_b64_tr_b16 v[220:221], v7 offset:27648
  ds_read_b64_tr_b16 v[222:223], v7 offset:28416
  s_waitcnt lgkmcnt(4)
  v_mfma_f32_32x32x16_bf16 v[144:159], v[212:215], v[96:99], v[144:159]
  ds_read_b64_tr_b16 v[224:225], v7 offset:27704
  ds_read_b64_tr_b16 v[226:227], v7 offset:28472
  s_waitcnt lgkmcnt(4)
  v_mfma_f32_32x32x16_bf16 v[160:175], v[216:219], v[96:99], v[160:175]
  ds_read_b64_tr_b16 v[228:229], v7 offset:27760
  ds_read_b64_tr_b16 v[230:231], v7 offset:28528
  s_waitcnt lgkmcnt(4)
  v_mfma_f32_32x32x16_bf16 v[128:143], v[220:223], v[100:103], v[128:143]
  ds_read_b64_tr_b16 v[208:209], v7 offset:30720
  ds_read_b64_tr_b16 v[210:211], v7 offset:31488
  s_waitcnt lgkmcnt(4)
  v_mfma_f32_32x32x16_bf16 v[144:159], v[224:227], v[100:103], v[144:159]
  ds_read_b64_tr_b16 v[212:213], v7 offset:30776
  ds_read_b64_tr_b16 v[214:215], v7 offset:31544
  s_waitcnt lgkmcnt(4)
  v_mfma_f32_32x32x16_bf16 v[160:175], v[228:231], v[100:103], v[160:175]
  ds_read_b64_tr_b16 v[216:217], v7 offset:30832
  ds_read_b64_tr_b16 v[218:219], v7 offset:31600
  s_waitcnt lgkmcnt(4)
  v_mfma_f32_32x32x16_bf16 v[128:143], v[208:211], v[104:107], v[128:143]
  ds_read_b64_tr_b16 v[220:221], v7 offset:33792
  ds_read_b64_tr_b16 v[222:223], v7 offset:34560
  s_waitcnt lgkmcnt(4)
  v_mfma_f32_32x32x16_bf16 v[144:159], v[212:215], v[104:107], v[144:159]
  ds_read_b64_tr_b16 v[224:225], v7 offset:33848
  ds_read_b64_tr_b16 v[226:227], v7 offset:34616
  s_waitcnt lgkmcnt(4)
  v_mfma_f32_32x32x16_bf16 v[160:175], v[216:219], v[104:107], v[160:175]
  ds_read_b64_tr_b16 v[228:229], v7 offset:33904
  ds_read_b64_tr_b16 v[230:231], v7 offset:34672
  s_waitcnt lgkmcnt(4)
  v_mfma_f32_32x32x16_bf16 v[128:143], v[220:223], v[108:111], v[128:143]
  s_waitcnt vmcnt(0)
  s_barrier
  ds_read_b64_tr_b16 v[208:209], v7 offset:36864
  ds_read_b64_tr_b16 v[210:211], v7 offset:37632
  s_waitcnt lgkmcnt(4)
  v_mfma_f32_32x32x16_bf16 v[144:159], v[224:227], v[108:111], v[144:159]
  ds_read_b64_tr_b16 v[212:213], v7 offset:36920
  ds_read_b64_tr_b16 v[214:215], v7 offset:37688
  s_waitcnt lgkmcnt(4)
  v_mfma_f32_32x32x16_bf16 v[160:175], v[228:231], v[108:111], v[160:175]
  ds_read_b64_tr_b16 v[216:217], v7 offset:36976
  ds_read_b64_tr_b16 v[218:219], v7 offset:37744
  s_waitcnt lgkmcnt(4)
  v_mfma_f32_32x32x16_bf16 v[128:143], v[208:211], v[112:115], v[128:143]
  ds_read_b64_tr_b16 v[220:221], v7 offset:39936
  ds_read_b64_tr_b16 v[222:223], v7 offset:40704
  s_waitcnt lgkmcnt(4)
  v_mfma_f32_32x32x16_bf16 v[144:159], v[212:215], v[112:115], v[144:159]
  ds_read_b64_tr_b16 v[224:225], v7 offset:39992
  ds_read_b64_tr_b16 v[226:227], v7 offset:40760
  s_waitcnt lgkmcnt(4)
  v_mfma_f32_32x32x16_bf16 v[160:175], v[216:219], v[112:115], v[160:175]
  ds_read_b64_tr_b16 v[228:229], v7 offset:40048
  ds_read_b64_tr_b16 v[230:231], v7 offset:40816
  s_waitcnt lgkmcnt(4)
  v_mfma_f32_32x32x16_bf16 v[128:143], v[220:223], v[116:119], v[128:143]
  ds_read_b64_tr_b16 v[208:209], v7 offset:43008
  ds_read_b64_tr_b16 v[210:211], v7 offset:43776
  s_waitcnt lgkmcnt(4)
  v_mfma_f32_32x32x16_bf16 v[144:159], v[224:227], v[116:119], v[144:159]
  ds_read_b64_tr_b16 v[212:213], v7 offset:43064
  ds_read_b64_tr_b16 v[214:215], v7 offset:43832
  s_waitcnt lgkmcnt(4)
  v_mfma_f32_32x32x16_bf16 v[160:175], v[228:231], v[116:119], v[160:175]
  ds_read_b64_tr_b16 v[216:217], v7 offset:43120
  ds_read_b64_tr_b16 v[218:219], v7 offset:43888
  s_waitcnt lgkmcnt(4)
  v_mfma_f32_32x32x16_bf16 v[128:143], v[208:211], v[120:123], v[128:143]
  ds_read_b64_tr_b16 v[220:221], v7 offset:46080
  ds_read_b64_tr_b16 v[222:223], v7 offset:46848
  s_waitcnt lgkmcnt(4)
  v_mfma_f32_32x32x16_bf16 v[144:159], v[212:215], v[120:123], v[144:159]
  ds_read_b64_tr_b16 v[224:225], v7 offset:46136
  ds_read_b64_tr_b16 v[226:227], v7 offset:46904
  s_waitcnt lgkmcnt(4)
  v_mfma_f32_32x32x16_bf16 v[160:175], v[216:219], v[120:123], v[160:175]
  ds_read_b64_tr_b16 v[228:229], v7 offset:46192
  ds_read_b64_tr_b16 v[230:231], v7 offset:46960
  s_waitcnt lgkmcnt(4)
  v_mfma_f32_32x32x16_bf16 v[128:143], v[220:223], v[124:127], v[128:143]
  s_waitcnt lgkmcnt(2)
  v_mfma_f32_32x32x16_bf16 v[144:159], v[224:227], v[124:127], v[144:159]
  s_waitcnt lgkmcnt(0)
  v_mfma_f32_32x32x16_bf16 v[160:175], v[228:231], v[124:127], v[160:175]
  s_barrier
  ds_read_b32 v208, v242 offset:0
  ds_read_b32 v212, v242 offset:256
  ds_read_b32 v216, v242 offset:512
  v_mov_b32 v209, 0
  v_mov_b32 v210, 0
  v_mov_b32 v211, 0
  v_mov_b32 v213, 0
  v_mov_b32 v214, 0
  v_mov_b32 v215, 0
  v_mov_b32 v217, 0
  v_mov_b32 v218, 0
  v_mov_b32 v219, 0
  v_mov_b32 v226, s40
  v_mul_f32 v220, s51, v236
  v_mov_b32 v221, v220
  v_mul_f32 v222, s52, v236
  v_mov_b32 v223, v222
  v_mul_f32 v224, s53, v236
  v_mov_b32 v225, v224
  s_waitcnt lgkmcnt(2)
  v_mfma_f32_32x32x16_bf16 v[128:143], v[208:211], v[244:247], v[128:143]
  s_waitcnt lgkmcnt(1)
  v_mfma_f32_32x32x16_bf16 v[144:159], v[212:215], v[244:247], v[144:159]
  s_waitcnt lgkmcnt(0)
  v_mfma_f32_32x32x16_bf16 v[160:175], v[216:219], v[244:247], v[160:175]
  s_nop 7
  v_pk_mul_f32 v[128:129], v[128:129], v[220:221]
  v_pk_mul_f32 v[130:131], v[130:131], v[220:221]
  v_pk_mul_f32 v[132:133], v[132:133], v[220:221]
  v_pk_mul_f32 v[134:135], v[134:135], v[220:221]
  v_pk_mul_f32 v[136:137], v[136:137], v[220:221]
  v_pk_mul_f32 v[138:139], v[138:139], v[220:221]
  v_pk_mul_f32 v[140:141], v[140:141], v[220:221]
  v_pk_mul_f32 v[142:143], v[142:143], v[220:221]
  v_cvt_pk_bf16_f32 v128, v128, v129
  v_cvt_pk_bf16_f32 v129, v130, v131
  v_cvt_pk_bf16_f32 v130, v132, v133
  v_cvt_pk_bf16_f32 v131, v134, v135
  v_cvt_pk_bf16_f32 v132, v136, v137
  v_cvt_pk_bf16_f32 v133, v138, v139
  v_cvt_pk_bf16_f32 v134, v140, v141
  v_cvt_pk_bf16_f32 v135, v142, v143
  v_cndmask_b32 v134, v134, v226, s[42:43]
  v_cndmask_b32 v135, v135, 0, s[42:43]
  buffer_store_dwordx4 v[128:131], v200, s[16:19], s48 offen sc1
  buffer_store_dwordx4 v[132:135], v201, s[16:19], s48 offen sc1
  v_pk_mul_f32 v[144:145], v[144:145], v[222:223]
  v_pk_mul_f32 v[146:147], v[146:147], v[222:223]
  v_pk_mul_f32 v[148:149], v[148:149], v[222:223]
  v_pk_mul_f32 v[150:151], v[150:151], v[222:223]
  v_pk_mul_f32 v[152:153], v[152:153], v[222:223]
  v_pk_mul_f32 v[154:155], v[154:155], v[222:223]
  v_pk_mul_f32 v[156:157], v[156:157], v[222:223]
  v_pk_mul_f32 v[158:159], v[158:159], v[222:223]
  v_cvt_pk_bf16_f32 v144, v144, v145
  v_cvt_pk_bf16_f32 v145, v146, v147
  v_cvt_pk_bf16_f32 v146, v148, v149
  v_cvt_pk_bf16_f32 v147, v150, v151
  v_cvt_pk_bf16_f32 v148, v152, v153
  v_cvt_pk_bf16_f32 v149, v154, v155
  v_cvt_pk_bf16_f32 v150, v156, v157
  v_cvt_pk_bf16_f32 v151, v158, v159
  v_cndmask_b32 v150, v150, v226, s[42:43]
  v_cndmask_b32 v151, v151, 0, s[42:43]
  buffer_store_dwordx4 v[144:147], v202, s[16:19], s49 offen sc1
  buffer_store_dwordx4 v[148:151], v203, s[16:19], s49 offen sc1
  v_pk_mul_f32 v[160:161], v[160:161], v[224:225]
  v_pk_mul_f32 v[162:163], v[162:163], v[224:225]
  v_pk_mul_f32 v[164:165], v[164:165], v[224:225]
  v_pk_mul_f32 v[166:167], v[166:167], v[224:225]
  v_pk_mul_f32 v[168:169], v[168:169], v[224:225]
  v_pk_mul_f32 v[170:171], v[170:171], v[224:225]
  v_pk_mul_f32 v[172:173], v[172:173], v[224:225]
  v_pk_mul_f32 v[174:175], v[174:175], v[224:225]
  v_cvt_pk_bf16_f32 v160, v160, v161
  v_cvt_pk_bf16_f32 v161, v162, v163
  v_cvt_pk_bf16_f32 v162, v164, v165
  v_cvt_pk_bf16_f32 v163, v166, v167
  v_cvt_pk_bf16_f32 v164, v168, v169
  v_cvt_pk_bf16_f32 v165, v170, v171
  v_cvt_pk_bf16_f32 v166, v172, v173
  v_cvt_pk_bf16_f32 v167, v174, v175
  v_cndmask_b32 v166, v166, v226, s[42:43]
  v_cndmask_b32 v167, v167, 0, s[42:43]
  buffer_store_dwordx4 v[160:163], v204, s[16:19], s50 offen sc1
  buffer_store_dwordx4 v[164:167], v205, s[16:19], s50 offen sc1
  v_add_u32 v232, 57344, v237
  v_add_u32 v240, 57344, v241
  v_lshlrev_b32 v243, 2, v1
  v_add_u32 v243, 152832, v243
  ds_read_b64_tr_b16 v[208:209], v237 offset:0
  ds_read_b64_tr_b16 v[210:211], v237 offset:512
  ds_read_b64_tr_b16 v[212:213], v237 offset:2048
  ds_read_b64_tr_b16 v[214:215], v237 offset:2560
  ds_read_b64_tr_b16 v[216:217], v237 offset:4096
  ds_read_b64_tr_b16 v[218:219], v237 offset:4608
  ds_read_b64_tr_b16 v[220:221], v237 offset:6144
  ds_read_b64_tr_b16 v[222:223], v237 offset:6656
  ds_read_b64_tr_b16 v[224:225], v237 offset:8192
  ds_read_b64_tr_b16 v[226:227], v237 offset:8704
  ds_read_b64_tr_b16 v[228:229], v237 offset:10240
  ds_read_b64_tr_b16 v[230:231], v237 offset:10752
  s_waitcnt lgkmcnt(8)
  v_mfma_f32_32x32x16_bf16 v[176:191], v[208:211], v[16:19], 0
  ds_read_b64_tr_b16 v[208:209], v237 offset:12288
  ds_read_b64_tr_b16 v[210:211], v237 offset:12800
  v_mfma_f32_32x32x16_bf16 v[176:191], v[212:215], v[20:23], v[176:191]
  ds_read_b64_tr_b16 v[212:213], v237 offset:14336
  ds_read_b64_tr_b16 v[214:215], v237 offset:14848
  v_lshlrev_b32 v4, 4, v1
  v_add_u32 v5, 1024, v4
  s_lshl_b32 s44, s34, 13
  v_add_u32 v2, s44, v4
  s_waitcnt lgkmcnt(8)
  v_mfma_f32_32x32x16_bf16 v[176:191], v[216:219], v[24:27], v[176:191]
  ds_read_b64_tr_b16 v[216:217], v237 offset:16384
  ds_read_b64_tr_b16 v[218:219], v237 offset:16896
  v_bfe_u32 v165, v1, 4, 1
  v_xor_b32 v165, s34, v165
  v_and_b32 v166, 1, v1
  v_lshrrev_b32 v167, 5, v1
  v_mfma_f32_32x32x16_bf16 v[176:191], v[220:223], v[28:31], v[176:191]
  ds_read_b64_tr_b16 v[220:221], v237 offset:18432
  ds_read_b64_tr_b16 v[222:223], v237 offset:18944
  v_xor_b32 v167, v167, v166
  v_lshlrev_b32 v167, 2, v167
  v_bfe_u32 v168, v1, 2, 2
  v_add_u32 v167, v167, v168
  s_waitcnt lgkmcnt(8)
  v_mfma_f32_32x32x16_bf16 v[176:191], v[224:227], v[32:35], v[176:191]
  ds_read_b64_tr_b16 v[224:225], v237 offset:20480
  ds_read_b64_tr_b16 v[226:227], v237 offset:20992
  v_lshlrev_b32 v167, 4, v167
  v_lshlrev_b32 v168, 10, v165
  v_add_u32 v167, v167, v168
  v_lshlrev_b32 v168, 9, v166
  v_mfma_f32_32x32x16_bf16 v[176:191], v[228:231], v[36:39], v[176:191]
  ds_read_b64_tr_b16 v[228:229], v237 offset:22528
  ds_read_b64_tr_b16 v[230:231], v237 offset:23040
  v_add_u32 v167, v167, v168
  v_bfe_u32 v168, v1, 1, 1
  v_lshlrev_b32 v168, 3, v168
  v_add_u32 v167, v167, v168
  s_waitcnt lgkmcnt(8)
  v_mfma_f32_32x32x16_bf16 v[176:191], v[208:211], v[40:43], v[176:191]
  ds_read_b64_tr_b16 v[208:209], v237 offset:24576
  ds_read_b64_tr_b16 v[210:211], v237 offset:25088
  s_add_u32 s44, s44, 2048
  v_add_u32 v167, s44, v167
  v_lshlrev_b32 v168, 7, v165
  v_add_u32 v3, v167, v168
  v_mfma_f32_32x32x16_bf16 v[176:191], v[212:215], v[44:47], v[176:191]
  ds_read_b64_tr_b16 v[212:213], v237 offset:26624
  ds_read_b64_tr_b16 v[214:215], v237 offset:27136
  v_xor_b32 v168, 128, v168
  v_add_u32 v10, v167, v168
  s_lshl_b32 s44, s32, 6
  s_lshl_b32 s45, s34, 5
  s_waitcnt lgkmcnt(8)
  v_mfma_f32_32x32x16_bf16 v[176:191], v[216:219], v[48:51], v[176:191]
  ds_read_b64_tr_b16 v[216:217], v237 offset:28672
  ds_read_b64_tr_b16 v[218:219], v237 offset:29184
  s_add_u32 s44, s44, s45
  s_lshl_b32 s44, s44, 12
  s_lshl_b32 s45, s35, 11
  s_add_u32 s44, s44, s45
  v_mfma_f32_32x32x16_bf16 v[176:191], v[220:223], v[52:55], v[176:191]
  ds_read_b64_tr_b16 v[220:221], v237 offset:30720
  ds_read_b64_tr_b16 v[222:223], v237 offset:31232
  s_add_u32 s48, s44, 2097152
  s_lshl_b32 s50, s34, 13
  s_add_u32 s50, s50, s45
  s_mov_b32 s8, s76
  s_waitcnt lgkmcnt(8)
  v_mfma_f32_32x32x16_bf16 v[176:191], v[224:227], v[56:59], v[176:191]
  ds_read_b64_tr_b16 v[224:225], v237 offset:32768
  ds_read_b64_tr_b16 v[226:227], v237 offset:33280
  s_and_b32 s9, s77, 0xffff
  s_mov_b32 s10, 0x188000
  s_mov_b32 s11, 0x00020000
  s_mov_b32 s12, s68
  v_mfma_f32_32x32x16_bf16 v[176:191], v[228:231], v[60:63], v[176:191]
  ds_read_b64_tr_b16 v[228:229], v237 offset:34816
  ds_read_b64_tr_b16 v[230:231], v237 offset:35328
  s_and_b32 s13, s69, 0xffff
  s_mov_b32 s14, 0x62000
  s_mov_b32 s15, 0x00020000
  v_lshrrev_b32 v165, 3, v1
  s_waitcnt lgkmcnt(8)
  v_mfma_f32_32x32x16_bf16 v[176:191], v[208:211], v[64:67], v[176:191]
  ds_read_b64_tr_b16 v[208:209], v237 offset:36864
  ds_read_b64_tr_b16 v[210:211], v237 offset:37376
  v_mul_u32_u24 v6, 896, v165
  v_bfe_u32 v165, v1, 4, 1
  v_lshlrev_b32 v165, 2, v165
  v_and_b32 v166, 7, v1
  v_mfma_f32_32x32x16_bf16 v[176:191], v[212:215], v[68:71], v[176:191]
  ds_read_b64_tr_b16 v[212:213], v237 offset:38912
  ds_read_b64_tr_b16 v[214:215], v237 offset:39424
  v_xor_b32 v166, v166, v165
  v_lshlrev_b32 v166, 4, v166
  v_add_u32 v6, v6, v166
  v_add_u32 v7, 13312, v6
  s_waitcnt lgkmcnt(8)
  v_mfma_f32_32x32x16_bf16 v[176:191], v[216:219], v[72:75], v[176:191]
  ds_read_b64_tr_b16 v[216:217], v237 offset:40960
  ds_read_b64_tr_b16 v[218:219], v237 offset:41472
  v_add_u32 v8, 26624, v6
  v_add_u32 v9, 39936, v6
  s_mul_i32 s56, s39, 448
  s_lshl_b32 s44, s38, 3
  v_mfma_f32_32x32x16_bf16 v[176:191], v[220:223], v[76:79], v[176:191]
  ds_read_b64_tr_b16 v[220:221], v237 offset:43008
  ds_read_b64_tr_b16 v[222:223], v237 offset:43520
  s_add_u32 s56, s56, s44
  s_mul_i32 s56, s56, 896
  s_lshl_b32 s45, s37, 7
  s_add_u32 s56, s56, s45
  s_waitcnt lgkmcnt(8)
  v_mfma_f32_32x32x16_bf16 v[176:191], v[224:227], v[80:83], v[176:191]
  ds_read_b64_tr_b16 v[224:225], v237 offset:45056
  ds_read_b64_tr_b16 v[226:227], v237 offset:45568
  s_mul_i32 s57, s39, 112
  s_add_u32 s57, s57, s44
  s_mul_i32 s57, s57, 896
  s_add_u32 s57, s57, s45
  v_mfma_f32_32x32x16_bf16 v[176:191], v[228:231], v[84:87], v[176:191]
  ds_read_b64_tr_b16 v[228:229], v237 offset:47104
  ds_read_b64_tr_b16 v[230:231], v237 offset:47616
  s_lshl_b32 s58, s26, 12
  s_lshl_b32 s44, s26, 11
  v_add_u32 v11, s44, v4
  s_xor_b32 s44, s44, 8192
  s_waitcnt lgkmcnt(8)
  v_mfma_f32_32x32x16_bf16 v[176:191], v[208:211], v[88:91], v[176:191]
  ds_read_b64_tr_b16 v[208:209], v237 offset:49152
  ds_read_b64_tr_b16 v[210:211], v237 offset:49664
  v_add_u32 v12, s44, v4
  s_lshl_b32 s44, s26, 8
  v_lshlrev_b32 v165, 2, v1
  v_add_u32 v13, s44, v165
  v_mfma_f32_32x32x16_bf16 v[176:191], v[212:215], v[92:95], v[176:191]
  ds_read_b64_tr_b16 v[212:213], v237 offset:51200
  ds_read_b64_tr_b16 v[214:215], v237 offset:51712
  s_xor_b32 s44, s44, 1024
  v_add_u32 v14, s44, v165
  v_and_b32 v15, 7, v1
  v_lshlrev_b32 v15, 2, v15
  s_waitcnt lgkmcnt(8)
  v_mfma_f32_32x32x16_bf16 v[176:191], v[216:219], v[96:99], v[176:191]
  ds_read_b64_tr_b16 v[216:217], v237 offset:53248
  ds_read_b64_tr_b16 v[218:219], v237 offset:53760
  s_lshl_b32 s54, s26, 2
  s_add_u32 s54, s54, 20480
  s_lshl_b32 s44, s33, 2
  s_add_u32 s44, s44, s35
  v_mfma_f32_32x32x16_bf16 v[176:191], v[220:223], v[100:103], v[176:191]
  ds_read_b64_tr_b16 v[220:221], v237 offset:55296
  ds_read_b64_tr_b16 v[222:223], v237 offset:55808
  s_lshl_b32 s44, s44, 4
  s_add_u32 s44, s44, s32
  s_lshl_b32 s44, s44, 11
  s_lshl_b32 s45, s34, 10
  s_waitcnt lgkmcnt(8)
  v_mfma_f32_32x32x16_bf16 v[176:191], v[224:227], v[104:107], v[176:191]
  ds_read_b64_tr_b16 v[224:225], v241 offset:0
  ds_read_b64_tr_b16 v[226:227], v241 offset:512
  s_add_u32 s44, s44, s45
  s_add_u32 s63, s44, 14680064
  v_mfma_f32_32x32x16_bf16 v[176:191], v[228:231], v[108:111], v[176:191]
  ds_read_b64_tr_b16 v[228:229], v241 offset:2048
  ds_read_b64_tr_b16 v[230:231], v241 offset:2560
  s_waitcnt lgkmcnt(8)
  v_mfma_f32_32x32x16_bf16 v[176:191], v[208:211], v[112:115], v[176:191]
  ds_read_b64_tr_b16 v[208:209], v241 offset:4096
  ds_read_b64_tr_b16 v[210:211], v241 offset:4608
  v_mfma_f32_32x32x16_bf16 v[176:191], v[212:215], v[116:119], v[176:191]
  ds_read_b64_tr_b16 v[212:213], v241 offset:6144
  ds_read_b64_tr_b16 v[214:215], v241 offset:6656
  s_waitcnt lgkmcnt(8)
  v_mfma_f32_32x32x16_bf16 v[176:191], v[216:219], v[120:123], v[176:191]
  ds_read_b64_tr_b16 v[216:217], v241 offset:8192
  ds_read_b64_tr_b16 v[218:219], v241 offset:8704
  v_mfma_f32_32x32x16_bf16 v[176:191], v[220:223], v[124:127], v[176:191]
  s_barrier
  ds_read_b64_tr_b16 v[220:221], v241 offset:10240
  ds_read_b64_tr_b16 v[222:223], v241 offset:10752
  s_waitcnt lgkmcnt(8)
  v_mfma_f32_32x32x16_bf16 v[192:207], v[224:227], v[16:19], 0
  ds_read_b64_tr_b16 v[224:225], v241 offset:12288
  ds_read_b64_tr_b16 v[226:227], v241 offset:12800
  v_mfma_f32_32x32x16_bf16 v[192:207], v[228:231], v[20:23], v[192:207]
  s_waitcnt vmcnt(0)
  v_mov_b32 v234, 153856
  v_mov_b32 v235, 1
  s_mov_b64 exec, 1
  ds_add_u32 v234, v235
  s_mov_b64 exec, -1
  ds_read_b64_tr_b16 v[228:229], v241 offset:14336
  ds_read_b64_tr_b16 v[230:231], v241 offset:14848
  ds_read_b32 v248, v243 offset:0
  ds_read_b128 v[128:131], v239 offset:0
  ds_read_b128 v[132:135], v239 offset:32
  s_waitcnt lgkmcnt(12)
  v_mfma_f32_32x32x16_bf16 v[192:207], v[208:211], v[24:27], v[192:207]
  ds_read_b64_tr_b16 v[208:209], v241 offset:16384
  ds_read_b64_tr_b16 v[210:211], v241 offset:16896
  v_mfma_f32_32x32x16_bf16 v[192:207], v[212:215], v[28:31], v[192:207]
  ds_read_b64_tr_b16 v[212:213], v241 offset:18432
  ds_read_b64_tr_b16 v[214:215], v241 offset:18944
  s_waitcnt lgkmcnt(6)
  v_mfma_f32_32x32x16_bf16 v[176:191], v[248:251], v[244:247], v[176:191]
  v_mfma_f32_32x32x16_bf16 v[192:207], v[216:219], v[32:35], v[192:207]
  ds_read_b64_tr_b16 v[216:217], v241 offset:20480
  ds_read_b64_tr_b16 v[218:219], v241 offset:20992
  v_mfma_f32_32x32x16_bf16 v[192:207], v[220:223], v[36:39], v[192:207]
  ds_read_b64_tr_b16 v[220:221], v241 offset:22528
  ds_read_b64_tr_b16 v[222:223], v241 offset:23040
  v_mfma_f32_32x32x16_bf16 v[192:207], v[224:227], v[40:43], v[192:207]
  ds_read_b64_tr_b16 v[224:225], v241 offset:24576
  ds_read_b64_tr_b16 v[226:227], v241 offset:25088
  s_waitcnt lgkmcnt(11)
  v_mfma_f32_32x32x16_bf16 v[192:207], v[228:231], v[44:47], v[192:207]
  ds_read_b64_tr_b16 v[228:229], v241 offset:26624
  ds_read_b64_tr_b16 v[230:231], v241 offset:27136
  v_fmac_f32 v128, v176, v236
  v_fmac_f32 v129, v177, v236
  v_fmac_f32 v130, v178, v236
  s_waitcnt lgkmcnt(8)
  v_mfma_f32_32x32x16_bf16 v[192:207], v[208:211], v[48:51], v[192:207]
  ds_read_b64_tr_b16 v[208:209], v241 offset:28672
  ds_read_b64_tr_b16 v[210:211], v241 offset:29184
  v_fmac_f32 v131, v179, v236
  v_max_f32 v128, 0, v128
  v_max_f32 v129, 0, v129
  v_mfma_f32_32x32x16_bf16 v[192:207], v[212:215], v[52:55], v[192:207]
  ds_read_b64_tr_b16 v[212:213], v241 offset:30720
  ds_read_b64_tr_b16 v[214:215], v241 offset:31232
  v_max_f32 v130, 0, v130
  v_max_f32 v131, 0, v131
  v_mul_f32 v128, v128, v128
  s_waitcnt lgkmcnt(8)
  v_mfma_f32_32x32x16_bf16 v[192:207], v[216:219], v[56:59], v[192:207]
  ds_read_b64_tr_b16 v[216:217], v241 offset:32768
  ds_read_b64_tr_b16 v[218:219], v241 offset:33280
  v_mul_f32 v129, v129, v129
  v_mul_f32 v130, v130, v130
  v_mul_f32 v131, v131, v131
  v_mfma_f32_32x32x16_bf16 v[192:207], v[220:223], v[60:63], v[192:207]
  ds_read_b64_tr_b16 v[220:221], v241 offset:34816
  ds_read_b64_tr_b16 v[222:223], v241 offset:35328
  v_cvt_pk_bf16_f32 v136, v128, v129
  v_cvt_pk_bf16_f32 v137, v130, v131
  ds_read_b128 v[128:131], v239 offset:64
  s_waitcnt lgkmcnt(9)
  v_mfma_f32_32x32x16_bf16 v[192:207], v[224:227], v[64:67], v[192:207]
  ds_read_b64_tr_b16 v[224:225], v241 offset:36864
  ds_read_b64_tr_b16 v[226:227], v241 offset:37376
  v_fmac_f32 v132, v180, v236
  v_fmac_f32 v133, v181, v236
  v_mfma_f32_32x32x16_bf16 v[192:207], v[228:231], v[68:71], v[192:207]
  ds_read_b64_tr_b16 v[228:229], v241 offset:38912
  ds_read_b64_tr_b16 v[230:231], v241 offset:39424
  v_fmac_f32 v134, v182, v236
  v_fmac_f32 v135, v183, v236
  v_max_f32 v132, 0, v132
  s_waitcnt lgkmcnt(9)
  v_mfma_f32_32x32x16_bf16 v[192:207], v[208:211], v[72:75], v[192:207]
  ds_read_b64_tr_b16 v[208:209], v241 offset:40960
  ds_read_b64_tr_b16 v[210:211], v241 offset:41472
  v_max_f32 v133, 0, v133
  v_max_f32 v134, 0, v134
  v_max_f32 v135, 0, v135
  v_mfma_f32_32x32x16_bf16 v[192:207], v[212:215], v[76:79], v[192:207]
  ds_read_b64_tr_b16 v[212:213], v241 offset:43008
  ds_read_b64_tr_b16 v[214:215], v241 offset:43520
  v_mul_f32 v132, v132, v132
  v_mul_f32 v133, v133, v133
  v_mul_f32 v134, v134, v134
  s_waitcnt lgkmcnt(9)
  v_mfma_f32_32x32x16_bf16 v[192:207], v[216:219], v[80:83], v[192:207]
  ds_read_b64_tr_b16 v[216:217], v241 offset:45056
  ds_read_b64_tr_b16 v[218:219], v241 offset:45568
  v_mul_f32 v135, v135, v135
  v_cvt_pk_bf16_f32 v138, v132, v133
  v_cvt_pk_bf16_f32 v139, v134, v135
  v_mfma_f32_32x32x16_bf16 v[192:207], v[220:223], v[84:87], v[192:207]
  ds_read_b64_tr_b16 v[220:221], v241 offset:47104
  ds_read_b64_tr_b16 v[222:223], v241 offset:47616
  ds_read_b128 v[132:135], v239 offset:96
  s_waitcnt lgkmcnt(13)
  v_fmac_f32 v128, v184, v236
  s_waitcnt lgkmcnt(9)
  v_mfma_f32_32x32x16_bf16 v[192:207], v[224:227], v[88:91], v[192:207]
  ds_read_b64_tr_b16 v[224:225], v241 offset:49152
  ds_read_b64_tr_b16 v[226:227], v241 offset:49664
  v_fmac_f32 v129, v185, v236
  v_fmac_f32 v130, v186, v236
  v_fmac_f32 v131, v187, v236
  v_mfma_f32_32x32x16_bf16 v[192:207], v[228:231], v[92:95], v[192:207]
  ds_read_b64_tr_b16 v[228:229], v241 offset:51200
  ds_read_b64_tr_b16 v[230:231], v241 offset:51712
  v_max_f32 v128, 0, v128
  v_max_f32 v129, 0, v129
  v_max_f32 v130, 0, v130
  s_waitcnt lgkmcnt(9)
  v_mfma_f32_32x32x16_bf16 v[192:207], v[208:211], v[96:99], v[192:207]
  ds_read_b64_tr_b16 v[208:209], v241 offset:53248
  ds_read_b64_tr_b16 v[210:211], v241 offset:53760
  v_max_f32 v131, 0, v131
  v_mul_f32 v128, v128, v128
  v_mul_f32 v129, v129, v129
  v_mfma_f32_32x32x16_bf16 v[192:207], v[212:215], v[100:103], v[192:207]
  s_barrier
  ds_read_b64_tr_b16 v[212:213], v241 offset:55296
  ds_read_b64_tr_b16 v[214:215], v241 offset:55808
  v_mul_f32 v130, v130, v130
  v_mul_f32 v131, v131, v131
  v_cvt_pk_bf16_f32 v140, v128, v129
  s_waitcnt lgkmcnt(9)
  v_mfma_f32_32x32x16_bf16 v[192:207], v[216:219], v[104:107], v[192:207]
  ds_read_b64_tr_b16 v[216:217], v232 offset:0
  ds_read_b64_tr_b16 v[218:219], v232 offset:512
  v_cvt_pk_bf16_f32 v141, v130, v131
  s_waitcnt lgkmcnt(10)
  v_fmac_f32 v132, v188, v236
  v_mfma_f32_32x32x16_bf16 v[192:207], v[220:223], v[108:111], v[192:207]
  ds_read_b64_tr_b16 v[220:221], v232 offset:2048
  ds_read_b64_tr_b16 v[222:223], v232 offset:2560
  v_fmac_f32 v133, v189, v236
  v_fmac_f32 v134, v190, v236
  v_fmac_f32 v135, v191, v236
  s_waitcnt lgkmcnt(8)
  v_mfma_f32_32x32x16_bf16 v[192:207], v[224:227], v[112:115], v[192:207]
  ds_read_b64_tr_b16 v[224:225], v232 offset:4096
  ds_read_b64_tr_b16 v[226:227], v232 offset:4608
  v_max_f32 v132, 0, v132
  v_max_f32 v133, 0, v133
  v_max_f32 v134, 0, v134
  v_mfma_f32_32x32x16_bf16 v[192:207], v[228:231], v[116:119], v[192:207]
  ds_read_b64_tr_b16 v[228:229], v232 offset:6144
  ds_read_b64_tr_b16 v[230:231], v232 offset:6656
  v_max_f32 v135, 0, v135
  v_mul_f32 v132, v132, v132
  v_mul_f32 v133, v133, v133
  s_waitcnt lgkmcnt(8)
  v_mfma_f32_32x32x16_bf16 v[192:207], v[208:211], v[120:123], v[192:207]
  ds_read_b64_tr_b16 v[208:209], v232 offset:8192
  ds_read_b64_tr_b16 v[210:211], v232 offset:8704
  v_mul_f32 v134, v134, v134
  v_mul_f32 v135, v135, v135
  v_cvt_pk_bf16_f32 v142, v132, v133
  v_mfma_f32_32x32x16_bf16 v[192:207], v[212:215], v[124:127], v[192:207]
  ds_read_b64_tr_b16 v[212:213], v232 offset:10240
  ds_read_b64_tr_b16 v[214:215], v232 offset:10752
  v_cvt_pk_bf16_f32 v143, v134, v135
  s_cmp_ge_u32 s25, 14
  s_cbranch_scc1 L_skipst_2
  s_add_u32 s44, s55, 0
  buffer_store_dwordx4 v[136:139], v238, s[16:19], s44 offen sc1
  buffer_store_dwordx4 v[140:143], v238, s[16:19], s44 offen offset:1024 sc1
L_skipst_2:
  s_waitcnt lgkmcnt(8)
  v_mfma_f32_32x32x16_bf16 v[176:191], v[216:219], v[16:19], 0
  ds_read_b64_tr_b16 v[216:217], v232 offset:12288
  ds_read_b64_tr_b16 v[218:219], v232 offset:12800
  v_mfma_f32_32x32x16_bf16 v[176:191], v[220:223], v[20:23], v[176:191]
  ds_read_b64_tr_b16 v[220:221], v232 offset:14336
  ds_read_b64_tr_b16 v[222:223], v232 offset:14848
  ds_read_b32 v248, v243 offset:256
  ds_read_b128 v[128:131], v239 offset:128
  ds_read_b128 v[132:135], v239 offset:160
  s_waitcnt lgkmcnt(11)
  v_mfma_f32_32x32x16_bf16 v[176:191], v[224:227], v[24:27], v[176:191]
  ds_read_b64_tr_b16 v[224:225], v232 offset:16384
  ds_read_b64_tr_b16 v[226:227], v232 offset:16896
  v_mfma_f32_32x32x16_bf16 v[176:191], v[228:231], v[28:31], v[176:191]
  ds_read_b64_tr_b16 v[228:229], v232 offset:18432
  ds_read_b64_tr_b16 v[230:231], v232 offset:18944
  s_waitcnt lgkmcnt(6)
  v_mfma_f32_32x32x16_bf16 v[192:207], v[248:251], v[244:247], v[192:207]
  v_mfma_f32_32x32x16_bf16 v[176:191], v[208:211], v[32:35], v[176:191]
  ds_read_b64_tr_b16 v[208:209], v232 offset:20480
  ds_read_b64_tr_b16 v[210:211], v232 offset:20992
  v_mfma_f32_32x32x16_bf16 v[176:191], v[212:215], v[36:39], v[176:191]
  ds_read_b64_tr_b16 v[212:213], v232 offset:22528
  ds_read_b64_tr_b16 v[214:215], v232 offset:23040
  v_mfma_f32_32x32x16_bf16 v[176:191], v[216:219], v[40:43], v[176:191]
  ds_read_b64_tr_b16 v[216:217], v232 offset:24576
  ds_read_b64_tr_b16 v[218:219], v232 offset:25088
  s_waitcnt lgkmcnt(11)
  v_mfma_f32_32x32x16_bf16 v[176:191], v[220:223], v[44:47], v[176:191]
  ds_read_b64_tr_b16 v[220:221], v232 offset:26624
  ds_read_b64_tr_b16 v[222:223], v232 offset:27136
  v_fmac_f32 v128, v192, v236
  v_fmac_f32 v129, v193, v236
  v_fmac_f32 v130, v194, v236
  s_waitcnt lgkmcnt(8)
  v_mfma_f32_32x32x16_bf16 v[176:191], v[224:227], v[48:51], v[176:191]
  ds_read_b64_tr_b16 v[224:225], v232 offset:28672
  ds_read_b64_tr_b16 v[226:227], v232 offset:29184
  v_fmac_f32 v131, v195, v236
  v_max_f32 v128, 0, v128
  v_max_f32 v129, 0, v129
  v_mfma_f32_32x32x16_bf16 v[176:191], v[228:231], v[52:55], v[176:191]
  ds_read_b64_tr_b16 v[228:229], v232 offset:30720
  ds_read_b64_tr_b16 v[230:231], v232 offset:31232
  v_max_f32 v130, 0, v130
  v_max_f32 v131, 0, v131
  v_mul_f32 v128, v128, v128
  s_waitcnt lgkmcnt(8)
  v_mfma_f32_32x32x16_bf16 v[176:191], v[208:211], v[56:59], v[176:191]
  ds_read_b64_tr_b16 v[208:209], v232 offset:32768
  ds_read_b64_tr_b16 v[210:211], v232 offset:33280
  v_mul_f32 v129, v129, v129
  v_mul_f32 v130, v130, v130
  v_mul_f32 v131, v131, v131
  v_mfma_f32_32x32x16_bf16 v[176:191], v[212:215], v[60:63], v[176:191]
  ds_read_b64_tr_b16 v[212:213], v232 offset:34816
  ds_read_b64_tr_b16 v[214:215], v232 offset:35328
  v_cvt_pk_bf16_f32 v136, v128, v129
  v_cvt_pk_bf16_f32 v137, v130, v131
  ds_read_b128 v[128:131], v239 offset:192
  s_waitcnt lgkmcnt(9)
  v_mfma_f32_32x32x16_bf16 v[176:191], v[216:219], v[64:67], v[176:191]
  ds_read_b64_tr_b16 v[216:217], v232 offset:36864
  ds_read_b64_tr_b16 v[218:219], v232 offset:37376
  v_fmac_f32 v132, v196, v236
  v_fmac_f32 v133, v197, v236
  v_mfma_f32_32x32x16_bf16 v[176:191], v[220:223], v[68:71], v[176:191]
  ds_read_b64_tr_b16 v[220:221], v232 offset:38912
  ds_read_b64_tr_b16 v[222:223], v232 offset:39424
  v_fmac_f32 v134, v198, v236
  v_fmac_f32 v135, v199, v236
  v_max_f32 v132, 0, v132
  s_waitcnt lgkmcnt(9)
  v_mfma_f32_32x32x16_bf16 v[176:191], v[224:227], v[72:75], v[176:191]
  ds_read_b64_tr_b16 v[224:225], v232 offset:40960
  ds_read_b64_tr_b16 v[226:227], v232 offset:41472
  v_max_f32 v133, 0, v133
  v_max_f32 v134, 0, v134
  v_max_f32 v135, 0, v135
  v_mfma_f32_32x32x16_bf16 v[176:191], v[228:231], v[76:79], v[176:191]
  ds_read_b64_tr_b16 v[228:229], v232 offset:43008
  ds_read_b64_tr_b16 v[230:231], v232 offset:43520
  v_mul_f32 v132, v132, v132
  v_mul_f32 v133, v133, v133
  v_mul_f32 v134, v134, v134
  s_waitcnt lgkmcnt(9)
  v_mfma_f32_32x32x16_bf16 v[176:191], v[208:211], v[80:83], v[176:191]
  ds_read_b64_tr_b16 v[208:209], v232 offset:45056
  ds_read_b64_tr_b16 v[210:211], v232 offset:45568
  v_mul_f32 v135, v135, v135
  v_cvt_pk_bf16_f32 v138, v132, v133
  v_cvt_pk_bf16_f32 v139, v134, v135
  v_mfma_f32_32x32x16_bf16 v[176:191], v[212:215], v[84:87], v[176:191]
  ds_read_b64_tr_b16 v[212:213], v232 offset:47104
  ds_read_b64_tr_b16 v[214:215], v232 offset:47616
  ds_read_b128 v[132:135], v239 offset:224
  s_waitcnt lgkmcnt(13)
  v_fmac_f32 v128, v200, v236
  s_waitcnt lgkmcnt(9)
  v_mfma_f32_32x32x16_bf16 v[176:191], v[216:219], v[88:91], v[176:191]
  ds_read_b64_tr_b16 v[216:217], v232 offset:49152
  ds_read_b64_tr_b16 v[218:219], v232 offset:49664
  v_fmac_f32 v129, v201, v236
  v_fmac_f32 v130, v202, v236
  v_fmac_f32 v131, v203, v236
  v_mfma_f32_32x32x16_bf16 v[176:191], v[220:223], v[92:95], v[176:191]
  ds_read_b64_tr_b16 v[220:221], v232 offset:51200
  ds_read_b64_tr_b16 v[222:223], v232 offset:51712
  v_max_f32 v128, 0, v128
  v_max_f32 v129, 0, v129
  v_max_f32 v130, 0, v130
  s_waitcnt lgkmcnt(9)
  v_mfma_f32_32x32x16_bf16 v[176:191], v[224:227], v[96:99], v[176:191]
  ds_read_b64_tr_b16 v[224:225], v232 offset:53248
  ds_read_b64_tr_b16 v[226:227], v232 offset:53760
  v_max_f32 v131, 0, v131
  v_mul_f32 v128, v128, v128
  v_mul_f32 v129, v129, v129
  v_mfma_f32_32x32x16_bf16 v[176:191], v[228:231], v[100:103], v[176:191]
  ds_read_b64_tr_b16 v[228:229], v232 offset:55296
  ds_read_b64_tr_b16 v[230:231], v232 offset:55808
  v_mul_f32 v130, v130, v130
  v_mul_f32 v131, v131, v131
  v_cvt_pk_bf16_f32 v140, v128, v129
  s_waitcnt lgkmcnt(9)
  v_mfma_f32_32x32x16_bf16 v[176:191], v[208:211], v[104:107], v[176:191]
  ds_read_b64_tr_b16 v[208:209], v240 offset:0
  ds_read_b64_tr_b16 v[210:211], v240 offset:512
  v_cvt_pk_bf16_f32 v141, v130, v131
  s_waitcnt lgkmcnt(10)
  v_fmac_f32 v132, v204, v236
  v_mfma_f32_32x32x16_bf16 v[176:191], v[212:215], v[108:111], v[176:191]
  ds_read_b64_tr_b16 v[212:213], v240 offset:2048
  ds_read_b64_tr_b16 v[214:215], v240 offset:2560
  v_fmac_f32 v133, v205, v236
  v_fmac_f32 v134, v206, v236
  v_fmac_f32 v135, v207, v236
  s_waitcnt lgkmcnt(8)
  v_mfma_f32_32x32x16_bf16 v[176:191], v[216:219], v[112:115], v[176:191]
  ds_read_b64_tr_b16 v[216:217], v240 offset:4096
  ds_read_b64_tr_b16 v[218:219], v240 offset:4608
  v_max_f32 v132, 0, v132
  v_max_f32 v133, 0, v133
  v_max_f32 v134, 0, v134
  v_mfma_f32_32x32x16_bf16 v[176:191], v[220:223], v[116:119], v[176:191]
  ds_read_b64_tr_b16 v[220:221], v240 offset:6144
  ds_read_b64_tr_b16 v[222:223], v240 offset:6656
  v_max_f32 v135, 0, v135
  v_mul_f32 v132, v132, v132
  v_mul_f32 v133, v133, v133
  s_waitcnt lgkmcnt(8)
  v_mfma_f32_32x32x16_bf16 v[176:191], v[224:227], v[120:123], v[176:191]
  ds_read_b64_tr_b16 v[224:225], v240 offset:8192
  ds_read_b64_tr_b16 v[226:227], v240 offset:8704
  v_mul_f32 v134, v134, v134
  v_mul_f32 v135, v135, v135
  v_cvt_pk_bf16_f32 v142, v132, v133
  v_mfma_f32_32x32x16_bf16 v[176:191], v[228:231], v[124:127], v[176:191]
  s_barrier
  ds_read_b64_tr_b16 v[228:229], v240 offset:10240
  ds_read_b64_tr_b16 v[230:231], v240 offset:10752
  v_cvt_pk_bf16_f32 v143, v134, v135
  s_cmp_ge_u32 s25, 14
  s_cbranch_scc1 L_skipst_3
  s_add_u32 s44, s55, 2048
  buffer_store_dwordx4 v[136:139], v238, s[16:19], s44 offen sc1
  buffer_store_dwordx4 v[140:143], v238, s[16:19], s44 offen offset:1024 sc1
L_skipst_3:
  s_waitcnt lgkmcnt(8)
  v_mfma_f32_32x32x16_bf16 v[192:207], v[208:211], v[16:19], 0
  s_lshl_b32 s44, s32, 6
  s_lshl_b32 s45, s33, 2
  s_add_u32 s44, s44, s45
  s_add_u32 s44, s44, s35
  s_lshl_b32 s44, s44, 11
  v_lshlrev_b32 v164, 4, v1
  buffer_load_dwordx4 v[156:159], v164, s[16:19], s44 offen sc1
  buffer_load_dwordx4 v[160:163], v164, s[16:19], s44 offen offset:1024 sc1
  ds_read_b64_tr_b16 v[208:209], v240 offset:12288
  ds_read_b64_tr_b16 v[210:211], v240 offset:12800
  v_mfma_f32_32x32x16_bf16 v[192:207], v[212:215], v[20:23], v[192:207]
  ds_read_b64_tr_b16 v[212:213], v240 offset:14336
  ds_read_b64_tr_b16 v[214:215], v240 offset:14848
  ds_read_b32 v248, v243 offset:512
  ds_read_b128 v[128:131], v239 offset:256
  ds_read_b128 v[132:135], v239 offset:288
  s_waitcnt lgkmcnt(11)
  v_mfma_f32_32x32x16_bf16 v[192:207], v[216:219], v[24:27], v[192:207]
  ds_read_b64_tr_b16 v[216:217], v240 offset:16384
  ds_read_b64_tr_b16 v[218:219], v240 offset:16896
  v_mfma_f32_32x32x16_bf16 v[192:207], v[220:223], v[28:31], v[192:207]
  ds_read_b64_tr_b16 v[220:221], v240 offset:18432
  ds_read_b64_tr_b16 v[222:223], v240 offset:18944
  s_waitcnt lgkmcnt(6)
  v_mfma_f32_32x32x16_bf16 v[176:191], v[248:251], v[244:247], v[176:191]
  v_mfma_f32_32x32x16_bf16 v[192:207], v[224:227], v[32:35], v[192:207]
  ds_read_b64_tr_b16 v[224:225], v240 offset:20480
  ds_read_b64_tr_b16 v[226:227], v240 offset:20992
  v_mfma_f32_32x32x16_bf16 v[192:207], v[228:231], v[36:39], v[192:207]
  ds_read_b64_tr_b16 v[228:229], v240 offset:22528
  ds_read_b64_tr_b16 v[230:231], v240 offset:23040
  v_mfma_f32_32x32x16_bf16 v[192:207], v[208:211], v[40:43], v[192:207]
  ds_read_b64_tr_b16 v[208:209], v240 offset:24576
  ds_read_b64_tr_b16 v[210:211], v240 offset:25088
  s_waitcnt lgkmcnt(11)
  v_mfma_f32_32x32x16_bf16 v[192:207], v[212:215], v[44:47], v[192:207]
  ds_read_b64_tr_b16 v[212:213], v240 offset:26624
  ds_read_b64_tr_b16 v[214:215], v240 offset:27136
  v_fmac_f32 v128, v176, v236
  v_fmac_f32 v129, v177, v236
  v_fmac_f32 v130, v178, v236
  s_waitcnt lgkmcnt(8)
  v_mfma_f32_32x32x16_bf16 v[192:207], v[216:219], v[48:51], v[192:207]
  ds_read_b64_tr_b16 v[216:217], v240 offset:28672
  ds_read_b64_tr_b16 v[218:219], v240 offset:29184
  v_fmac_f32 v131, v179, v236
  v_max_f32 v128, 0, v128
  v_max_f32 v129, 0, v129
  v_mfma_f32_32x32x16_bf16 v[192:207], v[220:223], v[52:55], v[192:207]
  ds_read_b64_tr_b16 v[220:221], v240 offset:30720
  ds_read_b64_tr_b16 v[222:223], v240 offset:31232
  v_max_f32 v130, 0, v130
  v_max_f32 v131, 0, v131
  v_mul_f32 v128, v128, v128
  s_waitcnt lgkmcnt(8)
  v_mfma_f32_32x32x16_bf16 v[192:207], v[224:227], v[56:59], v[192:207]
  ds_read_b64_tr_b16 v[224:225], v240 offset:32768
  ds_read_b64_tr_b16 v[226:227], v240 offset:33280
  v_mul_f32 v129, v129, v129
  v_mul_f32 v130, v130, v130
  v_mul_f32 v131, v131, v131
  v_mfma_f32_32x32x16_bf16 v[192:207], v[228:231], v[60:63], v[192:207]
  ds_read_b64_tr_b16 v[228:229], v240 offset:34816
  ds_read_b64_tr_b16 v[230:231], v240 offset:35328
  v_cvt_pk_bf16_f32 v136, v128, v129
  v_cvt_pk_bf16_f32 v137, v130, v131
  ds_read_b128 v[128:131], v239 offset:320
  s_waitcnt lgkmcnt(9)
  v_mfma_f32_32x32x16_bf16 v[192:207], v[208:211], v[64:67], v[192:207]
  ds_read_b64_tr_b16 v[208:209], v240 offset:36864
  ds_read_b64_tr_b16 v[210:211], v240 offset:37376
  v_fmac_f32 v132, v180, v236
  v_fmac_f32 v133, v181, v236
  v_mfma_f32_32x32x16_bf16 v[192:207], v[212:215], v[68:71], v[192:207]
  ds_read_b64_tr_b16 v[212:213], v240 offset:38912
  ds_read_b64_tr_b16 v[214:215], v240 offset:39424
  v_fmac_f32 v134, v182, v236
  v_fmac_f32 v135, v183, v236
  v_max_f32 v132, 0, v132
  s_waitcnt lgkmcnt(9)
  v_mfma_f32_32x32x16_bf16 v[192:207], v[216:219], v[72:75], v[192:207]
  ds_read_b64_tr_b16 v[216:217], v240 offset:40960
  ds_read_b64_tr_b16 v[218:219], v240 offset:41472
  v_max_f32 v133, 0, v133
  v_max_f32 v134, 0, v134
  v_max_f32 v135, 0, v135
  v_mfma_f32_32x32x16_bf16 v[192:207], v[220:223], v[76:79], v[192:207]
  ds_read_b64_tr_b16 v[220:221], v240 offset:43008
  ds_read_b64_tr_b16 v[222:223], v240 offset:43520
  v_mul_f32 v132, v132, v132
  v_mul_f32 v133, v133, v133
  v_mul_f32 v134, v134, v134
  s_waitcnt lgkmcnt(9)
  v_mfma_f32_32x32x16_bf16 v[192:207], v[224:227], v[80:83], v[192:207]
  ds_read_b64_tr_b16 v[224:225], v240 offset:45056
  ds_read_b64_tr_b16 v[226:227], v240 offset:45568
  v_mul_f32 v135, v135, v135
  v_cvt_pk_bf16_f32 v138, v132, v133
  v_cvt_pk_bf16_f32 v139, v134, v135
  v_mfma_f32_32x32x16_bf16 v[192:207], v[228:231], v[84:87], v[192:207]
  ds_read_b64_tr_b16 v[228:229], v240 offset:47104
  ds_read_b64_tr_b16 v[230:231], v240 offset:47616
  ds_read_b128 v[132:135], v239 offset:352
  s_waitcnt lgkmcnt(13)
  v_fmac_f32 v128, v184, v236
  s_waitcnt lgkmcnt(9)
  v_mfma_f32_32x32x16_bf16 v[192:207], v[208:211], v[88:91], v[192:207]
  ds_read_b64_tr_b16 v[208:209], v240 offset:49152
  ds_read_b64_tr_b16 v[210:211], v240 offset:49664
  v_fmac_f32 v129, v185, v236
  v_fmac_f32 v130, v186, v236
  v_fmac_f32 v131, v187, v236
  v_mfma_f32_32x32x16_bf16 v[192:207], v[212:215], v[92:95], v[192:207]
  ds_read_b64_tr_b16 v[212:213], v240 offset:51200
  ds_read_b64_tr_b16 v[214:215], v240 offset:51712
  v_max_f32 v128, 0, v128
  v_max_f32 v129, 0, v129
  v_max_f32 v130, 0, v130
  s_waitcnt lgkmcnt(9)
  v_mfma_f32_32x32x16_bf16 v[192:207], v[216:219], v[96:99], v[192:207]
  ds_read_b64_tr_b16 v[216:217], v240 offset:53248
  ds_read_b64_tr_b16 v[218:219], v240 offset:53760
  v_max_f32 v131, 0, v131
  v_mul_f32 v128, v128, v128
  v_mul_f32 v129, v129, v129
  v_mfma_f32_32x32x16_bf16 v[192:207], v[220:223], v[100:103], v[192:207]
  ds_read_b64_tr_b16 v[220:221], v240 offset:55296
  ds_read_b64_tr_b16 v[222:223], v240 offset:55808
  v_mul_f32 v130, v130, v130
  v_mul_f32 v131, v131, v131
  v_cvt_pk_bf16_f32 v140, v128, v129
  s_waitcnt lgkmcnt(9)
  v_mfma_f32_32x32x16_bf16 v[192:207], v[224:227], v[104:107], v[192:207]
  v_cvt_pk_bf16_f32 v141, v130, v131
  s_waitcnt lgkmcnt(8)
  v_fmac_f32 v132, v188, v236
  v_mfma_f32_32x32x16_bf16 v[192:207], v[228:231], v[108:111], v[192:207]
  v_fmac_f32 v133, v189, v236
  v_fmac_f32 v134, v190, v236
  v_fmac_f32 v135, v191, v236
  s_waitcnt lgkmcnt(4)
  v_mfma_f32_32x32x16_bf16 v[192:207], v[208:211], v[112:115], v[192:207]
  v_max_f32 v132, 0, v132
  v_max_f32 v133, 0, v133
  v_max_f32 v134, 0, v134
  v_mfma_f32_32x32x16_bf16 v[192:207], v[212:215], v[116:119], v[192:207]
  v_max_f32 v135, 0, v135
  v_mul_f32 v132, v132, v132
  v_mul_f32 v133, v133, v133
  s_waitcnt lgkmcnt(0)
  v_mfma_f32_32x32x16_bf16 v[192:207], v[216:219], v[120:123], v[192:207]
  v_mul_f32 v134, v134, v134
  v_mul_f32 v135, v135, v135
  v_cvt_pk_bf16_f32 v142, v132, v133
  v_mfma_f32_32x32x16_bf16 v[192:207], v[220:223], v[124:127], v[192:207]
  v_cvt_pk_bf16_f32 v143, v134, v135
  s_cmp_ge_u32 s25, 14
  s_cbranch_scc1 L_skipst_4
  s_add_u32 s44, s55, 4096
  buffer_store_dwordx4 v[136:139], v238, s[16:19], s44 offen sc1
  buffer_store_dwordx4 v[140:143], v238, s[16:19], s44 offen offset:1024 sc1
L_skipst_4:
  s_nop 7
  ds_read_b32 v248, v243 offset:768
  ds_read_b128 v[128:131], v239 offset:384
  ds_read_b128 v[132:135], v239 offset:416
  s_waitcnt lgkmcnt(2)
  v_mfma_f32_32x32x16_bf16 v[192:207], v[248:251], v[244:247], v[192:207]
  s_waitcnt lgkmcnt(1)
  s_nop 10
  v_fmac_f32 v128, v192, v236
  v_fmac_f32 v129, v193, v236
  v_fmac_f32 v130, v194, v236
  v_fmac_f32 v131, v195, v236
  v_max_f32 v128, 0, v128
  v_max_f32 v129, 0, v129
  v_max_f32 v130, 0, v130
  v_max_f32 v131, 0, v131
  v_mul_f32 v128, v128, v128
  v_mul_f32 v129, v129, v129
  v_mul_f32 v130, v130, v130
  v_mul_f32 v131, v131, v131
  v_cvt_pk_bf16_f32 v136, v128, v129
  v_cvt_pk_bf16_f32 v137, v130, v131
  ds_read_b128 v[128:131], v239 offset:448
  s_waitcnt lgkmcnt(1)
  v_fmac_f32 v132, v196, v236
  v_fmac_f32 v133, v197, v236
  v_fmac_f32 v134, v198, v236
  v_fmac_f32 v135, v199, v236
  v_max_f32 v132, 0, v132
  v_max_f32 v133, 0, v133
  v_max_f32 v134, 0, v134
  v_max_f32 v135, 0, v135
  v_mul_f32 v132, v132, v132
  v_mul_f32 v133, v133, v133
  v_mul_f32 v134, v134, v134
  v_mul_f32 v135, v135, v135
  v_cvt_pk_bf16_f32 v138, v132, v133
  v_cvt_pk_bf16_f32 v139, v134, v135
  ds_read_b128 v[132:135], v239 offset:480
  s_waitcnt lgkmcnt(1)
  v_fmac_f32 v128, v200, v236
  v_fmac_f32 v129, v201, v236
  v_fmac_f32 v130, v202, v236
  v_fmac_f32 v131, v203, v236
  v_max_f32 v128, 0, v128
  v_max_f32 v129, 0, v129
  v_max_f32 v130, 0, v130
  v_max_f32 v131, 0, v131
  v_mul_f32 v128, v128, v128
  v_mul_f32 v129, v129, v129
  v_mul_f32 v130, v130, v130
  v_mul_f32 v131, v131, v131
  v_cvt_pk_bf16_f32 v140, v128, v129
  v_cvt_pk_bf16_f32 v141, v130, v131
  s_waitcnt lgkmcnt(0)
  v_fmac_f32 v132, v204, v236
  v_fmac_f32 v133, v205, v236
  v_fmac_f32 v134, v206, v236
  v_fmac_f32 v135, v207, v236
  v_max_f32 v132, 0, v132
  v_max_f32 v133, 0, v133
  v_max_f32 v134, 0, v134
  v_max_f32 v135, 0, v135
  v_mul_f32 v132, v132, v132
  v_mul_f32 v133, v133, v133
  v_mul_f32 v134, v134, v134
  v_mul_f32 v135, v135, v135
  v_cvt_pk_bf16_f32 v142, v132, v133
  v_cvt_pk_bf16_f32 v143, v134, v135
  s_cmp_ge_u32 s25, 14
  s_cbranch_scc1 L_skipst_5
  s_add_u32 s44, s55, 6144
  buffer_store_dwordx4 v[136:139], v238, s[16:19], s44 offen sc1
  buffer_store_dwordx4 v[140:143], v238, s[16:19], s44 offen offset:1024 sc1
L_skipst_5:
  s_cmp_ge_u32 s25, 14
  s_cbranch_scc1 L_q_6
  s_waitcnt vmcnt(4)
  s_branch L_q2_7
L_q_6:
  s_waitcnt vmcnt(0)
L_q2_7:
  s_branch L_attn
L_helper:
  s_cmp_eq_u32 s26, 4
  s_cbranch_scc0 L_cswave
  v_lshlrev_b32 v20, 4, v1
  v_lshrrev_b32 v21, 6, v20
  v_mul_u32_u24 v21, 43, v21
  v_lshrrev_b32 v21, 7, v21
  v_mul_u32_u24 v22, 192, v21
  v_sub_u32 v22, v20, v22
  v_mul_u32_u24 v21, 2688, v21
  v_add_u32 v2, v21, v22
  v_lshlrev_b32 v20, 4, v1
  v_add_u32 v20, 1024, v20
  v_lshrrev_b32 v21, 6, v20
  v_mul_u32_u24 v21, 43, v21
  v_lshrrev_b32 v21, 7, v21
  v_mul_u32_u24 v22, 192, v21
  v_sub_u32 v22, v20, v22
  v_mul_u32_u24 v21, 2688, v21
  v_add_u32 v3, v21, v22
  v_lshlrev_b32 v20, 4, v1
  v_add_u32 v20, 2048, v20
  v_lshrrev_b32 v21, 6, v20
  v_mul_u32_u24 v21, 43, v21
  v_lshrrev_b32 v21, 7, v21
  v_mul_u32_u24 v22, 192, v21
  v_sub_u32 v22, v20, v22
  v_mul_u32_u24 v21, 2688, v21
  v_add_u32 v4, v21, v22
  s_mul_i32 s44, s25, 168
  s_and_b32 s45, s25, 1
  s_lshl_b32 s45, s45, 3
  s_sub_u32 s44, s44, s45
  v_lshrrev_b32 v21, 3, v1
  v_mul_u32_u24 v5, 3584, v21
  v_bfe_u32 v21, v1, 4, 1
  v_lshlrev_b32 v21, 2, v21
  v_and_b32 v22, 7, v1
  v_xor_b32 v22, v22, v21
  v_lshlrev_b32 v22, 4, v22
  v_add_u32 v5, v5, v22
  s_waitcnt lgkmcnt(0)
  s_mov_b32 s8, s66
  s_and_b32 s9, s67, 0xffff
  s_mov_b32 s10, 0x126000
  s_mov_b32 s11, 0x00020000
  s_mov_b32 s12, s72
  s_and_b32 s13, s73, 0xffff
  s_mov_b32 s14, 0x188000
  s_mov_b32 s15, 0x00020000
  s_mov_b32 s20, s74
  s_and_b32 s21, s75, 0xffff
  s_mov_b32 s22, 0xe00
  s_mov_b32 s23, 0x00020000
  s_mov_b32 s16, s84
  s_and_b32 s17, s85, 0xffff
  s_mov_b32 s18, 0x10000000
  s_mov_b32 s19, 0x00020000
  s_mov_b32 s4, s64
  s_and_b32 s5, s65, 0xffff
  s_mov_b32 s6, 0x1c0000
  s_mov_b32 s7, 0x00020000
  v_min_u32 v34, 8, v1
  v_lshlrev_b32 v34, 21, v34
  buffer_load_dword v35, v34, s[16:19], 0 offen
  v_min_u32 v34, 1, v1
  v_lshlrev_b32 v34, 20, v34
  global_load_dword v36, v34, s[80:81]
  s_cmp_lg_u32 s2, 0
  s_cbranch_scc1 L_nn_8
  s_memrealtime s[48:49]
  s_waitcnt lgkmcnt(0)
  s_or_b32 s48, s48, 1
  v_mov_b32 v30, 0
  v_mov_b32 v31, s48
  global_store_dword v30, v31, s[82:83] sc1
L_nn_8:
  s_lshl_b32 s50, s25, 8
  s_mov_b32 m0, 114688
  s_add_u32 s47, s44, 0
  buffer_load_dwordx4 v2, s[8:11], s47 offen lds
  s_mov_b32 m0, 115712
  s_nop 0
  buffer_load_dwordx4 v3, s[8:11], s47 offen lds
  s_mov_b32 m0, 116736
  s_nop 0
  buffer_load_dwordx4 v4, s[8:11], s47 offen lds
  s_barrier
  s_lshl_b32 s48, s25, 8
  v_lshlrev_b32 v20, 2, v1
  buffer_load_dword v21, v20, s[20:23], s48 offen
  s_mov_b32 m0, 126976
  s_add_u32 s47, s44, 172032
  buffer_load_dwordx4 v2, s[8:11], s47 offen lds
  s_mov_b32 m0, 128000
  s_nop 0
  buffer_load_dwordx4 v3, s[8:11], s47 offen lds
  s_mov_b32 m0, 129024
  s_nop 0
  buffer_load_dwordx4 v4, s[8:11], s47 offen lds
  s_mov_b32 m0, 139264
  s_add_u32 s47, s44, 344064
  buffer_load_dwordx4 v2, s[8:11], s47 offen lds
  s_mov_b32 m0, 140288
  s_nop 0
  buffer_load_dwordx4 v3, s[8:11], s47 offen lds
  s_mov_b32 m0, 141312
  s_nop 0
  buffer_load_dwordx4 v4, s[8:11], s47 offen lds
  s_waitcnt vmcnt(7)
  s_barrier
  v_mov_b32 v30, 0
  global_load_dword v31, v30, s[82:83] sc1
  s_waitcnt vmcnt(7)
  v_lshlrev_b32 v22, 16, v21
  v_and_b32 v23, 0xffff0000, v21
  v_lshlrev_b32 v20, 3, v1
  v_add_u32 v20, 151552, v20
  ds_write_b64 v20, v[22:23]
  s_waitcnt vmcnt(4)
  s_barrier
  s_lshl_b32 s52, s25, 8
  s_add_u32 s52, s52, 0
  s_mov_b32 s53, 0
  s_mov_b32 s54, 4
L_w1b_9:
  s_mov_b32 m0, s53
  s_add_u32 s53, s53, 4096
  buffer_load_dwordx4 v5, s[12:15], s52 offen lds
  s_add_u32 s52, s52, 114688
  s_sub_u32 s54, s54, 1
  s_cmp_lg_u32 s54, 0
  s_cbranch_scc1 L_w1b_9
  s_waitcnt vmcnt(5)
  s_barrier
  s_lshl_b32 s52, s25, 8
  s_add_u32 s52, s52, 458752
  s_mov_b32 s53, 16384
  s_mov_b32 s54, 4
L_w1b_10:
  s_mov_b32 m0, s53
  s_add_u32 s53, s53, 4096
  buffer_load_dwordx4 v5, s[12:15], s52 offen lds
  s_add_u32 s52, s52, 114688
  s_sub_u32 s54, s54, 1
  s_cmp_lg_u32 s54, 0
  s_cbranch_scc1 L_w1b_10
  s_barrier
  s_lshl_b32 s52, s25, 8
  s_add_u32 s52, s52, 917504
  s_mov_b32 s53, 32768
  s_mov_b32 s54, 3
L_w1b_11:
  s_mov_b32 m0, s53
  s_add_u32 s53, s53, 4096
  buffer_load_dwordx4 v5, s[12:15], s52 offen lds
  s_add_u32 s52, s52, 114688
  s_sub_u32 s54, s54, 1
  s_cmp_lg_u32 s54, 0
  s_cbranch_scc1 L_w1b_11
  s_barrier
  s_lshl_b32 s52, s25, 8
  s_add_u32 s52, s52, 1261568
  s_mov_b32 s53, 45056
  s_mov_b32 s54, 3
L_w1b_12:
  s_mov_b32 m0, s53
  s_add_u32 s53, s53, 4096
  buffer_load_dwordx4 v5, s[12:15], s52 offen lds
  s_add_u32 s52, s52, 114688
  s_sub_u32 s54, s54, 1
  s_cmp_lg_u32 s54, 0
  s_cbranch_scc1 L_w1b_12
  s_barrier
  s_lshl_b32 s52, s25, 8
  s_add_u32 s52, s52, 128
  s_mov_b32 s53, 57344
  s_mov_b32 s54, 5
L_w1b_13:
  s_mov_b32 m0, s53
  s_add_u32 s53, s53, 4096
  buffer_load_dwordx4 v5, s[12:15], s52 offen lds
  s_add_u32 s52, s52, 114688
  s_sub_u32 s54, s54, 1
  s_cmp_lg_u32 s54, 0
  s_cbranch_scc1 L_w1b_13
  s_waitcnt lgkmcnt(0)
  s_barrier
  s_lshl_b32 s52, s25, 8
  s_add_u32 s52, s52, 573568
  s_mov_b32 s53, 77824
  s_mov_b32 s54, 3
L_w1b_14:
  s_mov_b32 m0, s53
  s_add_u32 s53, s53, 4096
  buffer_load_dwordx4 v5, s[12:15], s52 offen lds
  s_add_u32 s52, s52, 114688
  s_sub_u32 s54, s54, 1
  s_cmp_lg_u32 s54, 0
  s_cbranch_scc1 L_w1b_14
  s_waitcnt vmcnt(8)
  s_barrier
  s_mov_b32 s62, 0x10000
L_gn_15:
  v_readfirstlane_b32 s61, v31
  s_nop 0
  s_cmp_lg_u32 s61, 0
  s_cbranch_scc1 L_gnd_16
  s_sub_u32 s62, s62, 1
  s_cmp_eq_u32 s62, 0
  s_cbranch_scc1 L_gnd_16
  s_sleep 1
  global_load_dword v31, v30, s[82:83] sc1
  s_waitcnt vmcnt(0)
  s_branch L_gn_15
L_gnd_16:
  s_lshl_b32 s52, s25, 8
  s_add_u32 s52, s52, 917632
  s_mov_b32 s53, 90112
  s_mov_b32 s54, 6
L_w1b_17:
  s_mov_b32 m0, s53
  s_add_u32 s53, s53, 4096
  buffer_load_dwordx4 v5, s[12:15], s52 offen lds
  s_add_u32 s52, s52, 114688
  s_sub_u32 s54, s54, 1
  s_cmp_lg_u32 s54, 0
  s_cbranch_scc1 L_w1b_17
  v_lshrrev_b32 v30, 4, v1
  v_min_u32 v30, 2, v30
  v_add_u32 v30, 1, v30
  v_cmp_eq_u32 vcc, 3, v30
  s_nop 1
  v_cndmask_b32 v30, v30, 0, vcc
  v_lshlrev_b32 v30, 4, v30
  v_add_u32 v30, s32, v30
  v_mul_u32_u24 v30, 43, v30
  v_lshrrev_b32 v30, 7, v30
  v_lshlrev_b32 v30, 7, v30
  v_and_b32 v31, 15, v1
  v_lshlrev_b32 v31, 2, v31
  v_add_u32 v30, v30, v31
  v_add_u32 v32, 16777216, v30
  s_lshl_b32 s48, s25, 7
  s_lshl_b32 s49, s24, 2
  s_add_u32 s48, s48, s49
  s_add_u32 s48, s48, 16777216
  s_barrier
  s_mov_b32 s62, 0x100000
  v_mov_b32 v33, 153856
L_cnt_18:
  ds_read_b32 v34, v33
  s_waitcnt lgkmcnt(0)
  v_readfirstlane_b32 s49, v34
  s_nop 0
  s_cmp_ge_u32 s49, 4
  s_cbranch_scc1 L_cntd_19
  s_sub_u32 s62, s62, 1
  s_cmp_eq_u32 s62, 0
  s_cbranch_scc1 L_cntd_19
  s_branch L_cnt_18
L_cntd_19:
  v_mov_b32 v30, s61
  v_mov_b32 v31, 0
  s_mov_b64 exec, 1
  buffer_store_dword v30, v31, s[16:19], s48 offen sc1
  s_mov_b64 exec, -1
  s_waitcnt vmcnt(1)
  s_barrier
  s_mov_b32 s62, 0x10000
L_poll_qkv_20:
  buffer_load_dword v33, v32, s[16:19], 0 offen sc1
  s_waitcnt vmcnt(0)
  v_cmp_ne_u32 vcc, s61, v33
  s_nop 0
  s_cbranch_vccz L_polld_qkv_21
  s_sub_u32 s62, s62, 1
  s_cmp_eq_u32 s62, 0
  s_cbranch_scc1 L_polld_qkv_21
  s_sleep 1
  s_branch L_poll_qkv_20
L_polld_qkv_21:
  s_barrier
  s_mov_b32 s27, 0
  s_lshl_b32 s44, s32, 6
  s_lshl_b32 s45, s33, 2
  s_add_u32 s44, s44, s45
  s_add_u32 s44, s44, s35
  s_lshl_b32 s44, s44, 11
  v_lshlrev_b32 v164, 4, v1
  buffer_load_dwordx4 v[156:159], v164, s[16:19], s44 offen sc1
  buffer_load_dwordx4 v[160:163], v164, s[16:19], s44 offen offset:1024 sc1
  s_lshl_b32 s44, s32, 18
  s_lshl_b32 s45, s27, 11
  s_add_u32 s44, s44, s45
  s_add_u32 s44, s44, 2097152
  v_lshlrev_b32 v30, 4, v1
  v_add_u32 v31, 1024, v30
  s_add_u32 m0, s45, 0
  s_add_u32 s46, s44, 0
  buffer_load_dwordx4 v30, s[16:19], s46 offen sc1 lds
  s_add_u32 m0, s45, 1024
  s_add_u32 s46, s44, 0
  buffer_load_dwordx4 v31, s[16:19], s46 offen sc1 lds
  s_add_u32 m0, s45, 8192
  s_add_u32 s46, s44, 131072
  buffer_load_dwordx4 v30, s[16:19], s46 offen sc1 lds
  s_add_u32 m0, s45, 9216
  s_add_u32 s46, s44, 131072
  buffer_load_dwordx4 v31, s[16:19], s46 offen sc1 lds
  s_add_u32 m0, s45, 16384
  s_add_u32 s46, s44, 8192
  buffer_load_dwordx4 v30, s[16:19], s46 offen sc1 lds
  s_add_u32 m0, s45, 17408
  s_add_u32 s46, s44, 8192
  buffer_load_dwordx4 v31, s[16:19], s46 offen sc1 lds
  s_add_u32 m0, s45, 24576
  s_add_u32 s46, s44, 139264
  buffer_load_dwordx4 v30, s[16:19], s46 offen sc1 lds
  s_add_u32 m0, s45, 25600
  s_add_u32 s46, s44, 139264
  buffer_load_dwordx4 v31, s[16:19], s46 offen sc1 lds
  s_add_u32 m0, s45, 32768
  s_add_u32 s46, s44, 16384
  buffer_load_dwordx4 v30, s[16:19], s46 offen sc1 lds
  s_add_u32 m0, s45, 33792
  s_add_u32 s46, s44, 16384
  buffer_load_dwordx4 v31, s[16:19], s46 offen sc1 lds
  s_add_u32 m0, s45, 40960
  s_add_u32 s46, s44, 147456
  buffer_load_dwordx4 v30, s[16:19], s46 offen sc1 lds
  s_add_u32 m0, s45, 41984
  s_add_u32 s46, s44, 147456
  buffer_load_dwordx4 v31, s[16:19], s46 offen sc1 lds
  v_lshlrev_b32 v4, 4, v1
  v_add_u32 v5, 1024, v4
  s_lshl_b32 s44, s34, 13
  v_add_u32 v2, s44, v4
  v_bfe_u32 v165, v1, 4, 1
  v_xor_b32 v165, s34, v165
  v_and_b32 v166, 1, v1
  v_lshrrev_b32 v167, 5, v1
  v_xor_b32 v167, v167, v166
  v_lshlrev_b32 v167, 2, v167
  v_bfe_u32 v168, v1, 2, 2
  v_add_u32 v167, v167, v168
  v_lshlrev_b32 v167, 4, v167
  v_lshlrev_b32 v168, 10, v165
  v_add_u32 v167, v167, v168
  v_lshlrev_b32 v168, 9, v166
  v_add_u32 v167, v167, v168
  v_bfe_u32 v168, v1, 1, 1
  v_lshlrev_b32 v168, 3, v168
  v_add_u32 v167, v167, v168
  s_add_u32 s44, s44, 2048
  v_add_u32 v167, s44, v167
  v_lshlrev_b32 v168, 7, v165
  v_add_u32 v3, v167, v168
  v_xor_b32 v168, 128, v168
  v_add_u32 v10, v167, v168
  s_lshl_b32 s44, s32, 6
  s_lshl_b32 s45, s34, 5
  s_add_u32 s44, s44, s45
  s_lshl_b32 s44, s44, 12
  s_lshl_b32 s45, s35, 11
  s_add_u32 s44, s44, s45
  s_add_u32 s48, s44, 2097152
  s_lshl_b32 s50, s34, 13
  s_add_u32 s50, s50, s45
  s_mov_b32 s8, s76
  s_and_b32 s9, s77, 0xffff
  s_mov_b32 s10, 0x188000
  s_mov_b32 s11, 0x00020000
  s_mov_b32 s12, s68
  s_and_b32 s13, s69, 0xffff
  s_mov_b32 s14, 0x62000
  s_mov_b32 s15, 0x00020000
  v_lshrrev_b32 v165, 3, v1
  v_mul_u32_u24 v6, 896, v165
  v_bfe_u32 v165, v1, 4, 1
  v_lshlrev_b32 v165, 2, v165
  v_and_b32 v166, 7, v1
  v_xor_b32 v166, v166, v165
  v_lshlrev_b32 v166, 4, v166
  v_add_u32 v6, v6, v166
  v_add_u32 v7, 13312, v6
  v_add_u32 v8, 26624, v6
  v_add_u32 v9, 39936, v6
  s_mul_i32 s56, s39, 448
  s_lshl_b32 s44, s38, 3
  s_add_u32 s56, s56, s44
  s_mul_i32 s56, s56, 896
  s_lshl_b32 s45, s37, 7
  s_add_u32 s56, s56, s45
  s_mul_i32 s57, s39, 112
  s_add_u32 s57, s57, s44
  s_mul_i32 s57, s57, 896
  s_add_u32 s57, s57, s45
  s_lshl_b32 s58, s26, 12
  s_lshl_b32 s44, s26, 11
  v_add_u32 v11, s44, v4
  s_xor_b32 s44, s44, 8192
  v_add_u32 v12, s44, v4
  s_lshl_b32 s44, s26, 8
  v_lshlrev_b32 v165, 2, v1
  v_add_u32 v13, s44, v165
  s_xor_b32 s44, s44, 1024
  v_add_u32 v14, s44, v165
  v_and_b32 v15, 7, v1
  v_lshlrev_b32 v15, 2, v15
  s_lshl_b32 s54, s26, 2
  s_add_u32 s54, s54, 20480
  s_lshl_b32 s44, s33, 2
  s_add_u32 s44, s44, s35
  s_lshl_b32 s44, s44, 4
  s_add_u32 s44, s44, s32
  s_lshl_b32 s44, s44, 11
  s_lshl_b32 s45, s34, 10
  s_add_u32 s44, s44, s45
  s_add_u32 s63, s44, 14680064
  s_waitcnt vmcnt(8)
  s_branch L_attn
L_cswave:
  s_sub_u32 s27, s26, 5
  v_lshrrev_b32 v24, 5, v1
  v_lshlrev_b32 v24, 3, v24
  v_bfe_u32 v25, v1, 2, 2
  v_add_u32 v24, v24, v25
  v_mul_u32_u24 v24, 192, v24
  v_bfe_u32 v25, v1, 4, 1
  v_lshlrev_b32 v25, 5, v25
  v_add_u32 v24, v24, v25
  v_and_b32 v25, 3, v1
  v_lshlrev_b32 v25, 3, v25
  v_add_u32 v24, v24, v25
  s_and_b32 s45, s25, 1
  s_lshl_b32 s45, s45, 3
  s_mul_i32 s49, s27, 56
  s_add_u32 s45, s45, s49
  s_add_u32 s49, s45, 114688
  v_add_u32 v6, s49, v24
  s_add_u32 s49, s45, 65536
  v_add_u32 v9, s49, v24
  v_and_b32 v20, 15, v1
  v_bfe_u32 v21, v1, 4, 1
  v_cmp_eq_u32 vcc, v20, v21
  v_mov_b32 v22, s40
  s_nop 0
  v_cndmask_b32 v12, 0, v22, vcc
  v_cndmask_b32 v13, 0, v22, vcc
  v_cndmask_b32 v14, 0, v22, vcc
  v_cndmask_b32 v15, 0, v22, vcc
  v_lshlrev_b32 v20, 4, v1
  v_lshrrev_b32 v21, 6, v20
  v_mul_u32_u24 v21, 43, v21
  v_lshrrev_b32 v21, 7, v21
  v_mul_u32_u24 v22, 192, v21
  v_sub_u32 v22, v20, v22
  v_mul_u32_u24 v21, 2688, v21
  v_add_u32 v2, v21, v22
  v_lshlrev_b32 v20, 4, v1
  v_add_u32 v20, 1024, v20
  v_lshrrev_b32 v21, 6, v20
  v_mul_u32_u24 v21, 43, v21
  v_lshrrev_b32 v21, 7, v21
  v_mul_u32_u24 v22, 192, v21
  v_sub_u32 v22, v20, v22
  v_mul_u32_u24 v21, 2688, v21
  v_add_u32 v3, v21, v22
  v_lshlrev_b32 v20, 4, v1
  v_add_u32 v20, 2048, v20
  v_lshrrev_b32 v21, 6, v20
  v_mul_u32_u24 v21, 43, v21
  v_lshrrev_b32 v21, 7, v21
  v_mul_u32_u24 v22, 192, v21
  v_sub_u32 v22, v20, v22
  v_mul_u32_u24 v21, 2688, v21
  v_add_u32 v4, v21, v22
  v_lshrrev_b32 v21, 3, v1
  v_mul_u32_u24 v5, 3584, v21
  v_bfe_u32 v21, v1, 4, 1
  v_lshlrev_b32 v21, 2, v21
  v_and_b32 v22, 7, v1
  v_xor_b32 v22, v22, v21
  v_lshlrev_b32 v22, 4, v22
  v_add_u32 v5, v5, v22
  s_add_u32 s63, s27, 1
  s_mul_i32 s44, s63, 43008
  s_mul_i32 s45, s25, 168
  s_add_u32 s44, s44, s45
  s_and_b32 s45, s25, 1
  s_lshl_b32 s45, s45, 3
  s_sub_u32 s44, s44, s45
  s_mul_i32 s46, s63, 3072
  s_waitcnt lgkmcnt(0)
  s_mov_b32 s4, s64
  s_and_b32 s5, s65, 0xffff
  s_mov_b32 s6, 0x1c0000
  s_mov_b32 s7, 0x00020000
  s_mov_b32 s16, s84
  s_and_b32 s17, s85, 0xffff
  s_mov_b32 s18, 0x10000000
  s_mov_b32 s19, 0x00020000
  s_mov_b32 s8, s66
  s_and_b32 s9, s67, 0xffff
  s_mov_b32 s10, 0x126000
  s_mov_b32 s11, 0x00020000
  s_mov_b32 s12, s72
  s_and_b32 s13, s73, 0xffff
  s_mov_b32 s14, 0x188000
  s_mov_b32 s15, 0x00020000
  v_lshlrev_b32 v20, 2, v1
  v_add_u32 v20, 152064, v20
  v_mov_b32 v21, 0
  s_mov_b64 exec, s[42:43]
  ds_write_b32 v20, v21 offset:0
  ds_write_b32 v20, v21 offset:256
  ds_write_b32 v20, v21 offset:512
  ds_write_b32 v20, v21 offset:768
  ds_write_b32 v20, v21 offset:1024
  ds_write_b32 v20, v21 offset:1280
  ds_write_b32 v20, v21 offset:1536
  s_mov_b64 exec, -1
  v_mov_b32 v20, 153856
  ds_write_b32 v20, v21
  v_lshlrev_b32 v52, 4, v1
  s_cmp_eq_u32 s27, 1
  s_cbranch_scc1 L_pf1_22
  s_cmp_eq_u32 s27, 2
  s_cbranch_scc1 L_pf2_23
  s_mul_i32 s56, s2, 4704
  buffer_load_dwordx4 v[48:51], v52, s[8:11], s56 offen offset:0
  buffer_load_dwordx4 v[48:51], v52, s[8:11], s56 offen offset:1024
  s_branch L_pfe_24
L_pf1_22:
  s_mul_i32 s56, s2, 4704
  s_add_u32 s56, s56, 2048
  buffer_load_dwordx4 v[48:51], v52, s[8:11], s56 offen offset:0
  buffer_load_dwordx4 v[48:51], v52, s[8:11], s56 offen offset:1024
  s_branch L_pfe_24
L_pf2_23:
  s_mul_i32 s56, s2, 4704
  s_add_u32 s56, s56, 4096
  buffer_load_dwordx4 v[48:51], v52, s[8:11], s56 offen offset:0
L_pfe_24:
  s_add_u32 m0, s46, 114688
  s_add_u32 s47, s44, 0
  buffer_load_dwordx4 v2, s[8:11], s47 offen lds
  s_add_u32 m0, s46, 115712
  s_nop 0
  buffer_load_dwordx4 v3, s[8:11], s47 offen lds
  s_add_u32 m0, s46, 116736
  s_nop 0
  buffer_load_dwordx4 v4, s[8:11], s47 offen lds
  s_barrier
  s_add_u32 m0, s46, 126976
  s_add_u32 s47, s44, 172032
  buffer_load_dwordx4 v2, s[8:11], s47 offen lds
  s_add_u32 m0, s46, 128000
  s_nop 0
  buffer_load_dwordx4 v3, s[8:11], s47 offen lds
  s_add_u32 m0, s46, 129024
  s_nop 0
  buffer_load_dwordx4 v4, s[8:11], s47 offen lds
  s_add_u32 m0, s46, 139264
  s_add_u32 s47, s44, 344064
  buffer_load_dwordx4 v2, s[8:11], s47 offen lds
  s_add_u32 m0, s46, 140288
  s_nop 0
  buffer_load_dwordx4 v3, s[8:11], s47 offen lds
  s_add_u32 m0, s46, 141312
  s_nop 0
  buffer_load_dwordx4 v4, s[8:11], s47 offen lds
  v_lshlrev_b32 v52, 4, v1
  s_cmp_eq_u32 s27, 1
  s_cbranch_scc1 L_pf1_25
  s_cmp_eq_u32 s27, 2
  s_cbranch_scc1 L_pf2_26
  s_mul_i32 s56, s2, 6272
  buffer_load_dwordx4 v[48:51], v52, s[12:15], s56 offen offset:0
  buffer_load_dwordx4 v[48:51], v52, s[12:15], s56 offen offset:1024
  buffer_load_dwordx4 v[48:51], v52, s[12:15], s56 offen offset:2048
  buffer_load_dwordx4 v[48:51], v52, s[12:15], s56 offen offset:3072
  s_add_u32 s56, s56, 4096
  buffer_load_dwordx4 v[48:51], v52, s[12:15], s56 offen offset:0
  buffer_load_dwordx4 v[48:51], v52, s[12:15], s56 offen offset:1024
  s_branch L_pfe_27
L_pf1_25:
  s_mov_b32 s20, s76
  s_and_b32 s21, s77, 0xffff
  s_mov_b32 s22, 0x188000
  s_mov_b32 s23, 0x00020000
  s_mul_i32 s56, s2, 6272
  buffer_load_dwordx4 v[48:51], v52, s[20:23], s56 offen offset:0
  buffer_load_dwordx4 v[48:51], v52, s[20:23], s56 offen offset:1024
  buffer_load_dwordx4 v[48:51], v52, s[20:23], s56 offen offset:2048
  buffer_load_dwordx4 v[48:51], v52, s[20:23], s56 offen offset:3072
  s_add_u32 s56, s56, 4096
  buffer_load_dwordx4 v[48:51], v52, s[20:23], s56 offen offset:0
  buffer_load_dwordx4 v[48:51], v52, s[20:23], s56 offen offset:1024
  s_branch L_pfe_27
L_pf2_26:
  s_mul_i32 s56, s2, 6272
  s_add_u32 s56, s56, 6144
  buffer_load_dwordx4 v[48:51], v52, s[12:15], s56 offen offset:0
  s_mov_b32 s20, s76
  s_and_b32 s21, s77, 0xffff
  s_mov_b32 s22, 0x188000
  s_mov_b32 s23, 0x00020000
  s_mul_i32 s56, s2, 6272
  s_add_u32 s56, s56, 6144
  buffer_load_dwordx4 v[48:51], v52, s[20:23], s56 offen offset:0
  s_mov_b32 s20, s68
  s_and_b32 s21, s69, 0xffff
  s_mov_b32 s22, 0x62000
  s_mov_b32 s23, 0x00020000
  s_mul_i32 s56, s2, 1568
  buffer_load_dwordx4 v[48:51], v52, s[20:23], s56 offen offset:0
  buffer_load_dwordx4 v[48:51], v52, s[20:23], s56 offen offset:1024
  s_mul_i32 s56, s2, 1568
  buffer_load_dwordx4 v[48:51], v52, s[20:23], s56 offen offset:0
  buffer_load_dwordx4 v[48:51], v52, s[20:23], s56 offen offset:1024
L_pfe_27:
  s_waitcnt vmcnt(12)
  s_barrier
  ds_read_b64_tr_b16 v[32:33], v6 offset:0
  ds_read_b64_tr_b16 v[34:35], v6 offset:768
  ds_read_b64_tr_b16 v[36:37], v6 offset:3072
  ds_read_b64_tr_b16 v[38:39], v6 offset:3840
  ds_read_b64_tr_b16 v[40:41], v6 offset:6144
  ds_read_b64_tr_b16 v[42:43], v6 offset:6912
  ds_read_b64_tr_b16 v[44:45], v6 offset:9216
  ds_read_b64_tr_b16 v[46:47], v6 offset:9984
  s_waitcnt lgkmcnt(6)
  v_mfma_f32_16x16x32_bf16 v[16:19], v[12:15], v[32:35], 0
  s_waitcnt lgkmcnt(4)
  v_mfma_f32_16x16x32_bf16 v[16:19], v[12:15], v[36:39], v[16:19]
  s_waitcnt lgkmcnt(2)
  v_mfma_f32_16x16x32_bf16 v[16:19], v[12:15], v[40:43], v[16:19]
  s_waitcnt lgkmcnt(0)
  v_mfma_f32_16x16x32_bf16 v[16:19], v[12:15], v[44:47], v[16:19]
  s_waitcnt vmcnt(9)
  s_barrier
  s_mul_i32 s52, s63, 28672
  s_lshl_b32 s53, s25, 8
  s_add_u32 s52, s52, s53
  s_add_u32 s52, s52, 0
  s_lshl_b32 s53, s63, 10
  s_add_u32 s53, s53, 0
  s_mov_b32 s54, 4
L_w1b_28:
  s_mov_b32 m0, s53
  s_add_u32 s53, s53, 4096
  buffer_load_dwordx4 v5, s[12:15], s52 offen lds
  s_add_u32 s52, s52, 114688
  s_sub_u32 s54, s54, 1
  s_cmp_lg_u32 s54, 0
  s_cbranch_scc1 L_w1b_28
  ds_read_b64_tr_b16 v[32:33], v6 offset:12288
  ds_read_b64_tr_b16 v[34:35], v6 offset:13056
  ds_read_b64_tr_b16 v[36:37], v6 offset:15360
  ds_read_b64_tr_b16 v[38:39], v6 offset:16128
  ds_read_b64_tr_b16 v[40:41], v6 offset:18432
  ds_read_b64_tr_b16 v[42:43], v6 offset:19200
  ds_read_b64_tr_b16 v[44:45], v6 offset:21504
  ds_read_b64_tr_b16 v[46:47], v6 offset:22272
  s_waitcnt lgkmcnt(6)
  v_mfma_f32_16x16x32_bf16 v[16:19], v[12:15], v[32:35], v[16:19]
  s_waitcnt lgkmcnt(4)
  v_mfma_f32_16x16x32_bf16 v[16:19], v[12:15], v[36:39], v[16:19]
  s_waitcnt lgkmcnt(2)
  v_mfma_f32_16x16x32_bf16 v[16:19], v[12:15], v[40:43], v[16:19]
  s_waitcnt lgkmcnt(0)
  v_mfma_f32_16x16x32_bf16 v[16:19], v[12:15], v[44:47], v[16:19]
  s_waitcnt vmcnt(10)
  s_barrier
  s_mul_i32 s52, s63, 28672
  s_lshl_b32 s53, s25, 8
  s_add_u32 s52, s52, s53
  s_add_u32 s52, s52, 458752
  s_lshl_b32 s53, s63, 10
  s_add_u32 s53, s53, 16384
  s_mov_b32 s54, 4
L_w1b_29:
  s_mov_b32 m0, s53
  s_add_u32 s53, s53, 4096
  buffer_load_dwordx4 v5, s[12:15], s52 offen lds
  s_add_u32 s52, s52, 114688
  s_sub_u32 s54, s54, 1
  s_cmp_lg_u32 s54, 0
  s_cbranch_scc1 L_w1b_29
  ds_read_b64_tr_b16 v[32:33], v6 offset:24576
  ds_read_b64_tr_b16 v[34:35], v6 offset:25344
  ds_read_b64_tr_b16 v[36:37], v6 offset:27648
  ds_read_b64_tr_b16 v[38:39], v6 offset:28416
  ds_read_b64_tr_b16 v[40:41], v6 offset:30720
  ds_read_b64_tr_b16 v[42:43], v6 offset:31488
  ds_read_b64_tr_b16 v[44:45], v6 offset:33792
  ds_read_b64_tr_b16 v[46:47], v6 offset:34560
  s_waitcnt lgkmcnt(6)
  v_mfma_f32_16x16x32_bf16 v[16:19], v[12:15], v[32:35], v[16:19]
  s_waitcnt lgkmcnt(4)
  v_mfma_f32_16x16x32_bf16 v[16:19], v[12:15], v[36:39], v[16:19]
  s_waitcnt lgkmcnt(2)
  v_mfma_f32_16x16x32_bf16 v[16:19], v[12:15], v[40:43], v[16:19]
  s_waitcnt lgkmcnt(0)
  v_mfma_f32_16x16x32_bf16 v[16:19], v[12:15], v[44:47], v[16:19]
  s_barrier
  s_mul_i32 s52, s63, 28672
  s_lshl_b32 s53, s25, 8
  s_add_u32 s52, s52, s53
  s_add_u32 s52, s52, 917504
  s_lshl_b32 s53, s63, 10
  s_add_u32 s53, s53, 32768
  s_mov_b32 s54, 3
L_w1b_30:
  s_mov_b32 m0, s53
  s_add_u32 s53, s53, 4096
  buffer_load_dwordx4 v5, s[12:15], s52 offen lds
  s_add_u32 s52, s52, 114688
  s_sub_u32 s54, s54, 1
  s_cmp_lg_u32 s54, 0
  s_cbranch_scc1 L_w1b_30
  ds_read_b64_tr_b16 v[32:33], v9 offset:0
  ds_read_b64_tr_b16 v[34:35], v9 offset:768
  ds_read_b64_tr_b16 v[36:37], v9 offset:3072
  ds_read_b64_tr_b16 v[38:39], v9 offset:3840
  ds_read_b64_tr_b16 v[40:41], v9 offset:6144
  ds_read_b64_tr_b16 v[42:43], v9 offset:6912
  ds_read_b64_tr_b16 v[44:45], v9 offset:9216
  ds_read_b64_tr_b16 v[46:47], v9 offset:9984
  s_waitcnt lgkmcnt(6)
  v_mfma_f32_16x16x32_bf16 v[16:19], v[12:15], v[32:35], v[16:19]
  s_waitcnt lgkmcnt(4)
  v_mfma_f32_16x16x32_bf16 v[16:19], v[12:15], v[36:39], v[16:19]
  s_waitcnt lgkmcnt(2)
  v_mfma_f32_16x16x32_bf16 v[16:19], v[12:15], v[40:43], v[16:19]
  s_waitcnt lgkmcnt(0)
  v_mfma_f32_16x16x32_bf16 v[16:19], v[12:15], v[44:47], v[16:19]
  s_barrier
  s_mul_i32 s52, s63, 28672
  s_lshl_b32 s53, s25, 8
  s_add_u32 s52, s52, s53
  s_add_u32 s52, s52, 1261568
  s_lshl_b32 s53, s63, 10
  s_add_u32 s53, s53, 45056
  s_mov_b32 s54, 3
L_w1b_31:
  s_mov_b32 m0, s53
  s_add_u32 s53, s53, 4096
  buffer_load_dwordx4 v5, s[12:15], s52 offen lds
  s_add_u32 s52, s52, 114688
  s_sub_u32 s54, s54, 1
  s_cmp_lg_u32 s54, 0
  s_cbranch_scc1 L_w1b_31
  ds_read_b64_tr_b16 v[32:33], v9 offset:12288
  ds_read_b64_tr_b16 v[34:35], v9 offset:13056
  ds_read_b64_tr_b16 v[36:37], v9 offset:15360
  ds_read_b64_tr_b16 v[38:39], v9 offset:16128
  ds_read_b64_tr_b16 v[40:41], v9 offset:18432
  ds_read_b64_tr_b16 v[42:43], v9 offset:19200
  ds_read_b64_tr_b16 v[44:45], v9 offset:21504
  ds_read_b64_tr_b16 v[46:47], v9 offset:22272
  s_waitcnt lgkmcnt(6)
  v_mfma_f32_16x16x32_bf16 v[16:19], v[12:15], v[32:35], v[16:19]
  s_waitcnt lgkmcnt(4)
  v_mfma_f32_16x16x32_bf16 v[16:19], v[12:15], v[36:39], v[16:19]
  s_waitcnt lgkmcnt(2)
  v_mfma_f32_16x16x32_bf16 v[16:19], v[12:15], v[40:43], v[16:19]
  s_waitcnt lgkmcnt(0)
  v_mfma_f32_16x16x32_bf16 v[16:19], v[12:15], v[44:47], v[16:19]
  s_barrier
  s_mul_i32 s52, s63, 28672
  s_lshl_b32 s53, s25, 8
  s_add_u32 s52, s52, s53
  s_add_u32 s52, s52, 128
  s_lshl_b32 s53, s63, 10
  s_add_u32 s53, s53, 57344
  s_mov_b32 s54, 5
L_w1b_32:
  s_mov_b32 m0, s53
  s_add_u32 s53, s53, 4096
  buffer_load_dwordx4 v5, s[12:15], s52 offen lds
  s_add_u32 s52, s52, 114688
  s_sub_u32 s54, s54, 1
  s_cmp_lg_u32 s54, 0
  s_cbranch_scc1 L_w1b_32
  ds_read_b64_tr_b16 v[32:33], v9 offset:24576
  ds_read_b64_tr_b16 v[34:35], v9 offset:25344
  ds_read_b64_tr_b16 v[36:37], v9 offset:27648
  ds_read_b64_tr_b16 v[38:39], v9 offset:28416
  ds_read_b64_tr_b16 v[40:41], v9 offset:30720
  ds_read_b64_tr_b16 v[42:43], v9 offset:31488
  ds_read_b64_tr_b16 v[44:45], v9 offset:33792
  ds_read_b64_tr_b16 v[46:47], v9 offset:34560
  s_waitcnt lgkmcnt(6)
  v_mfma_f32_16x16x32_bf16 v[16:19], v[12:15], v[32:35], v[16:19]
  s_waitcnt lgkmcnt(4)
  v_mfma_f32_16x16x32_bf16 v[16:19], v[12:15], v[36:39], v[16:19]
  s_waitcnt lgkmcnt(2)
  v_mfma_f32_16x16x32_bf16 v[16:19], v[12:15], v[40:43], v[16:19]
  s_waitcnt lgkmcnt(0)
  v_mfma_f32_16x16x32_bf16 v[16:19], v[12:15], v[44:47], v[16:19]
  s_barrier
  s_mul_i32 s52, s63, 28672
  s_lshl_b32 s53, s25, 8
  s_add_u32 s52, s52, s53
  s_add_u32 s52, s52, 573568
  s_lshl_b32 s53, s63, 10
  s_add_u32 s53, s53, 77824
  s_mov_b32 s54, 3
L_w1b_33:
  s_mov_b32 m0, s53
  s_add_u32 s53, s53, 4096
  buffer_load_dwordx4 v5, s[12:15], s52 offen lds
  s_add_u32 s52, s52, 114688
  s_sub_u32 s54, s54, 1
  s_cmp_lg_u32 s54, 0
  s_cbranch_scc1 L_w1b_33
  ds_read_b64_tr_b16 v[32:33], v9 offset:36864
  ds_read_b64_tr_b16 v[34:35], v9 offset:37632
  ds_read_b64_tr_b16 v[36:37], v9 offset:39936
  ds_read_b64_tr_b16 v[38:39], v9 offset:40704
  ds_read_b64_tr_b16 v[40:41], v9 offset:43008
  ds_read_b64_tr_b16 v[42:43], v9 offset:43776
  ds_read_b64_tr_b16 v[44:45], v9 offset:46080
  ds_read_b64_tr_b16 v[46:47], v9 offset:46848
  s_waitcnt lgkmcnt(6)
  v_mfma_f32_16x16x32_bf16 v[16:19], v[12:15], v[32:35], v[16:19]
  s_waitcnt lgkmcnt(4)
  v_mfma_f32_16x16x32_bf16 v[16:19], v[12:15], v[36:39], v[16:19]
  s_waitcnt lgkmcnt(2)
  v_mfma_f32_16x16x32_bf16 v[16:19], v[12:15], v[40:43], v[16:19]
  s_waitcnt lgkmcnt(0)
  v_mfma_f32_16x16x32_bf16 v[16:19], v[12:15], v[44:47], v[16:19]
  s_lshl_b32 s49, s27, 8
  s_add_u32 s49, s49, 152064
  s_nop 7
  v_cvt_pk_bf16_f32 v24, v16, v16
  v_lshlrev_b32 v24, 16, v24
  v_sub_f32 v25, v16, v24
  v_cvt_pk_bf16_f32 v26, v24, v25
  v_cvt_pk_bf16_f32 v24, v17, v17
  v_lshlrev_b32 v24, 16, v24
  v_sub_f32 v25, v17, v24
  v_cvt_pk_bf16_f32 v27, v24, v25
  v_lshlrev_b32 v24, 2, v1
  v_add_u32 v24, s49, v24
  s_mov_b64 exec, 0xffff
  ds_write_b32 v24, v26
  ds_write_b32 v24, v27 offset:64
  s_mov_b64 exec, -1
  s_waitcnt lgkmcnt(0)
  s_waitcnt vmcnt(8)
  s_barrier
  s_mul_i32 s52, s63, 28672
  s_lshl_b32 s53, s25, 8
  s_add_u32 s52, s52, s53
  s_add_u32 s52, s52, 917632
  s_lshl_b32 s53, s63, 10
  s_add_u32 s53, s53, 90112
  s_mov_b32 s54, 6
L_w1b_34:
  s_mov_b32 m0, s53
  s_add_u32 s53, s53, 4096
  buffer_load_dwordx4 v5, s[12:15], s52 offen lds
  s_add_u32 s52, s52, 114688
  s_sub_u32 s54, s54, 1
  s_cmp_lg_u32 s54, 0
  s_cbranch_scc1 L_w1b_34
  v_lshrrev_b32 v24, 5, v1
  v_mul_u32_u24 v24, 8, v24
  v_bfe_u32 v25, v1, 2, 2
  v_add_u32 v24, v24, v25
  v_lshlrev_b32 v9, 7, v24
  v_bfe_u32 v24, v1, 4, 1
  v_lshlrev_b32 v24, 5, v24
  v_and_b32 v25, 3, v1
  v_lshlrev_b32 v25, 3, v25
  v_add_u32 v24, v24, v25
  v_bfe_u32 v25, v1, 3, 1
  v_lshlrev_b32 v25, 6, v25
  v_xor_b32 v24, v24, v25
  v_add_u32 v9, v9, v24
  s_mov_b32 s54, 0
L_csround:
  s_mov_b32 s55, s27
  s_cmp_eq_u32 s54, 0
  s_cbranch_scc1 L_r0_36
  s_cmp_eq_u32 s27, 1
  s_cbranch_scc1 L_csskip_35
  s_cmp_eq_u32 s27, 0
  s_cselect_b32 s55, 3, 2
  s_branch L_csgo
L_r0_36:
  s_cmp_eq_u32 s27, 2
  s_cbranch_scc1 L_csskip_35
L_csgo:
  s_and_b32 s49, s55, 1
  s_lshl_b32 s49, s49, 6
  v_xor_b32 v32, s49, v9
  s_lshr_b32 s49, s55, 1
  s_mul_i32 s49, s49, 57344
  v_add_u32 v32, s49, v32
  ds_read_b64_tr_b16 v[40:41], v32 offset:0
  ds_read_b64_tr_b16 v[42:43], v32 offset:512
  ds_read_b64_tr_b16 v[44:45], v32 offset:2048
  ds_read_b64_tr_b16 v[46:47], v32 offset:2560
  ds_read_b64_tr_b16 v[48:49], v32 offset:4096
  ds_read_b64_tr_b16 v[50:51], v32 offset:4608
  ds_read_b64_tr_b16 v[52:53], v32 offset:6144
  ds_read_b64_tr_b16 v[54:55], v32 offset:6656
  ds_read_b64_tr_b16 v[56:57], v32 offset:8192
  ds_read_b64_tr_b16 v[58:59], v32 offset:8704
  ds_read_b64_tr_b16 v[60:61], v32 offset:10240
  ds_read_b64_tr_b16 v[62:63], v32 offset:10752
  s_waitcnt lgkmcnt(10)
  v_mfma_f32_16x16x32_bf16 v[16:19], v[12:15], v[40:43], 0
  ds_read_b64_tr_b16 v[40:41], v32 offset:12288
  ds_read_b64_tr_b16 v[42:43], v32 offset:12800
  s_waitcnt lgkmcnt(10)
  v_mfma_f32_16x16x32_bf16 v[16:19], v[12:15], v[44:47], v[16:19]
  ds_read_b64_tr_b16 v[44:45], v32 offset:14336
  ds_read_b64_tr_b16 v[46:47], v32 offset:14848
  s_waitcnt lgkmcnt(10)
  v_mfma_f32_16x16x32_bf16 v[16:19], v[12:15], v[48:51], v[16:19]
  ds_read_b64_tr_b16 v[48:49], v32 offset:16384
  ds_read_b64_tr_b16 v[50:51], v32 offset:16896
  s_waitcnt lgkmcnt(10)
  v_mfma_f32_16x16x32_bf16 v[16:19], v[12:15], v[52:55], v[16:19]
  ds_read_b64_tr_b16 v[52:53], v32 offset:18432
  ds_read_b64_tr_b16 v[54:55], v32 offset:18944
  s_waitcnt lgkmcnt(10)
  v_mfma_f32_16x16x32_bf16 v[16:19], v[12:15], v[56:59], v[16:19]
  ds_read_b64_tr_b16 v[56:57], v32 offset:20480
  ds_read_b64_tr_b16 v[58:59], v32 offset:20992
  s_waitcnt lgkmcnt(10)
  v_mfma_f32_16x16x32_bf16 v[16:19], v[12:15], v[60:63], v[16:19]
  ds_read_b64_tr_b16 v[60:61], v32 offset:22528
  ds_read_b64_tr_b16 v[62:63], v32 offset:23040
  s_waitcnt lgkmcnt(10)
  v_mfma_f32_16x16x32_bf16 v[16:19], v[12:15], v[40:43], v[16:19]
  ds_read_b64_tr_b16 v[40:41], v32 offset:24576
  ds_read_b64_tr_b16 v[42:43], v32 offset:25088
  s_waitcnt lgkmcnt(10)
  v_mfma_f32_16x16x32_bf16 v[16:19], v[12:15], v[44:47], v[16:19]
  ds_read_b64_tr_b16 v[44:45], v32 offset:26624
  ds_read_b64_tr_b16 v[46:47], v32 offset:27136
  s_waitcnt lgkmcnt(10)
  v_mfma_f32_16x16x32_bf16 v[16:19], v[12:15], v[48:51], v[16:19]
  ds_read_b64_tr_b16 v[48:49], v32 offset:28672
  ds_read_b64_tr_b16 v[50:51], v32 offset:29184
  s_waitcnt lgkmcnt(10)
  v_mfma_f32_16x16x32_bf16 v[16:19], v[12:15], v[52:55], v[16:19]
  ds_read_b64_tr_b16 v[52:53], v32 offset:30720
  ds_read_b64_tr_b16 v[54:55], v32 offset:31232
  s_waitcnt lgkmcnt(10)
  v_mfma_f32_16x16x32_bf16 v[16:19], v[12:15], v[56:59], v[16:19]
  ds_read_b64_tr_b16 v[56:57], v32 offset:32768
  ds_read_b64_tr_b16 v[58:59], v32 offset:33280
  s_waitcnt lgkmcnt(10)
  v_mfma_f32_16x16x32_bf16 v[16:19], v[12:15], v[60:63], v[16:19]
  ds_read_b64_tr_b16 v[60:61], v32 offset:34816
  ds_read_b64_tr_b16 v[62:63], v32 offset:35328
  s_waitcnt lgkmcnt(10)
  v_mfma_f32_16x16x32_bf16 v[16:19], v[12:15], v[40:43], v[16:19]
  ds_read_b64_tr_b16 v[40:41], v32 offset:36864
  ds_read_b64_tr_b16 v[42:43], v32 offset:37376
  s_waitcnt lgkmcnt(10)
  v_mfma_f32_16x16x32_bf16 v[16:19], v[12:15], v[44:47], v[16:19]
  ds_read_b64_tr_b16 v[44:45], v32 offset:38912
  ds_read_b64_tr_b16 v[46:47], v32 offset:39424
  s_waitcnt lgkmcnt(10)
  v_mfma_f32_16x16x32_bf16 v[16:19], v[12:15], v[48:51], v[16:19]
  ds_read_b64_tr_b16 v[48:49], v32 offset:40960
  ds_read_b64_tr_b16 v[50:51], v32 offset:41472
  s_waitcnt lgkmcnt(10)
  v_mfma_f32_16x16x32_bf16 v[16:19], v[12:15], v[52:55], v[16:19]
  ds_read_b64_tr_b16 v[52:53], v32 offset:43008
  ds_read_b64_tr_b16 v[54:55], v32 offset:43520
  s_waitcnt lgkmcnt(10)
  v_mfma_f32_16x16x32_bf16 v[16:19], v[12:15], v[56:59], v[16:19]
  ds_read_b64_tr_b16 v[56:57], v32 offset:45056
  ds_read_b64_tr_b16 v[58:59], v32 offset:45568
  s_waitcnt lgkmcnt(10)
  v_mfma_f32_16x16x32_bf16 v[16:19], v[12:15], v[60:63], v[16:19]
  ds_read_b64_tr_b16 v[60:61], v32 offset:47104
  ds_read_b64_tr_b16 v[62:63], v32 offset:47616
  s_waitcnt lgkmcnt(10)
  v_mfma_f32_16x16x32_bf16 v[16:19], v[12:15], v[40:43], v[16:19]
  ds_read_b64_tr_b16 v[40:41], v32 offset:49152
  ds_read_b64_tr_b16 v[42:43], v32 offset:49664
  s_waitcnt lgkmcnt(10)
  v_mfma_f32_16x16x32_bf16 v[16:19], v[12:15], v[44:47], v[16:19]
  ds_read_b64_tr_b16 v[44:45], v32 offset:51200
  ds_read_b64_tr_b16 v[46:47], v32 offset:51712
  s_waitcnt lgkmcnt(10)
  v_mfma_f32_16x16x32_bf16 v[16:19], v[12:15], v[48:51], v[16:19]
  ds_read_b64_tr_b16 v[48:49], v32 offset:53248
  ds_read_b64_tr_b16 v[50:51], v32 offset:53760
  s_waitcnt lgkmcnt(10)
  v_mfma_f32_16x16x32_bf16 v[16:19], v[12:15], v[52:55], v[16:19]
  ds_read_b64_tr_b16 v[52:53], v32 offset:55296
  ds_read_b64_tr_b16 v[54:55], v32 offset:55808
  s_waitcnt lgkmcnt(10)
  v_mfma_f32_16x16x32_bf16 v[16:19], v[12:15], v[56:59], v[16:19]
  s_waitcnt lgkmcnt(8)
  v_mfma_f32_16x16x32_bf16 v[16:19], v[12:15], v[60:63], v[16:19]
  s_waitcnt lgkmcnt(6)
  v_mfma_f32_16x16x32_bf16 v[16:19], v[12:15], v[40:43], v[16:19]
  s_waitcnt lgkmcnt(4)
  v_mfma_f32_16x16x32_bf16 v[16:19], v[12:15], v[44:47], v[16:19]
  s_waitcnt lgkmcnt(2)
  v_mfma_f32_16x16x32_bf16 v[16:19], v[12:15], v[48:51], v[16:19]
  s_waitcnt lgkmcnt(0)
  v_mfma_f32_16x16x32_bf16 v[16:19], v[12:15], v[52:55], v[16:19]
  s_add_u32 s49, s55, 3
  s_lshl_b32 s49, s49, 8
  s_add_u32 s49, s49, 152064
  s_nop 7
  v_cvt_pk_bf16_f32 v24, v16, v16
  v_lshlrev_b32 v24, 16, v24
  v_sub_f32 v25, v16, v24
  v_cvt_pk_bf16_f32 v26, v24, v25
  v_cvt_pk_bf16_f32 v24, v17, v17
  v_lshlrev_b32 v24, 16, v24
  v_sub_f32 v25, v17, v24
  v_cvt_pk_bf16_f32 v27, v24, v25
  v_lshlrev_b32 v24, 2, v1
  v_add_u32 v24, s49, v24
  s_mov_b64 exec, 0xffff
  ds_write_b32 v24, v26
  ds_write_b32 v24, v27 offset:64
  s_mov_b64 exec, -1
  s_waitcnt lgkmcnt(0)
L_csskip_35:
  s_cmp_eq_u32 s54, 1
  s_cbranch_scc1 L_csdone
  s_barrier
  s_waitcnt vmcnt(0)
  s_barrier
  s_mov_b32 s54, 1
  s_branch L_csround
L_csdone:
  s_barrier
  s_add_u32 s62, s27, 1
  s_lshl_b32 s44, s32, 6
  s_lshl_b32 s45, s33, 2
  s_add_u32 s44, s44, s45
  s_add_u32 s44, s44, s35
  s_lshl_b32 s44, s44, 11
  v_lshlrev_b32 v164, 4, v1
  buffer_load_dwordx4 v[156:159], v164, s[16:19], s44 offen sc1
  buffer_load_dwordx4 v[160:163], v164, s[16:19], s44 offen offset:1024 sc1
  s_lshl_b32 s44, s32, 18
  s_lshl_b32 s45, s62, 11
  s_add_u32 s44, s44, s45
  s_add_u32 s44, s44, 2097152
  v_lshlrev_b32 v30, 4, v1
  v_add_u32 v31, 1024, v30
  s_add_u32 m0, s45, 0
  s_add_u32 s46, s44, 0
  buffer_load_dwordx4 v30, s[16:19], s46 offen sc1 lds
  s_add_u32 m0, s45, 1024
  s_add_u32 s46, s44, 0
  buffer_load_dwordx4 v31, s[16:19], s46 offen sc1 lds
  s_add_u32 m0, s45, 8192
  s_add_u32 s46, s44, 131072
  buffer_load_dwordx4 v30, s[16:19], s46 offen sc1 lds
  s_add_u32 m0, s45, 9216
  s_add_u32 s46, s44, 131072
  buffer_load_dwordx4 v31, s[16:19], s46 offen sc1 lds
  s_add_u32 m0, s45, 16384
  s_add_u32 s46, s44, 8192
  buffer_load_dwordx4 v30, s[16:19], s46 offen sc1 lds
  s_add_u32 m0, s45, 17408
  s_add_u32 s46, s44, 8192
  buffer_load_dwordx4 v31, s[16:19], s46 offen sc1 lds
  s_add_u32 m0, s45, 24576
  s_add_u32 s46, s44, 139264
  buffer_load_dwordx4 v30, s[16:19], s46 offen sc1 lds
  s_add_u32 m0, s45, 25600
  s_add_u32 s46, s44, 139264
  buffer_load_dwordx4 v31, s[16:19], s46 offen sc1 lds
  s_add_u32 m0, s45, 32768
  s_add_u32 s46, s44, 16384
  buffer_load_dwordx4 v30, s[16:19], s46 offen sc1 lds
  s_add_u32 m0, s45, 33792
  s_add_u32 s46, s44, 16384
  buffer_load_dwordx4 v31, s[16:19], s46 offen sc1 lds
  s_add_u32 m0, s45, 40960
  s_add_u32 s46, s44, 147456
  buffer_load_dwordx4 v30, s[16:19], s46 offen sc1 lds
  s_add_u32 m0, s45, 41984
  s_add_u32 s46, s44, 147456
  buffer_load_dwordx4 v31, s[16:19], s46 offen sc1 lds
  v_lshlrev_b32 v4, 4, v1
  v_add_u32 v5, 1024, v4
  s_lshl_b32 s44, s34, 13
  v_add_u32 v2, s44, v4
  v_bfe_u32 v165, v1, 4, 1
  v_xor_b32 v165, s34, v165
  v_and_b32 v166, 1, v1
  v_lshrrev_b32 v167, 5, v1
  v_xor_b32 v167, v167, v166
  v_lshlrev_b32 v167, 2, v167
  v_bfe_u32 v168, v1, 2, 2
  v_add_u32 v167, v167, v168
  v_lshlrev_b32 v167, 4, v167
  v_lshlrev_b32 v168, 10, v165
  v_add_u32 v167, v167, v168
  v_lshlrev_b32 v168, 9, v166
  v_add_u32 v167, v167, v168
  v_bfe_u32 v168, v1, 1, 1
  v_lshlrev_b32 v168, 3, v168
  v_add_u32 v167, v167, v168
  s_add_u32 s44, s44, 2048
  v_add_u32 v167, s44, v167
  v_lshlrev_b32 v168, 7, v165
  v_add_u32 v3, v167, v168
  v_xor_b32 v168, 128, v168
  v_add_u32 v10, v167, v168
  s_lshl_b32 s44, s32, 6
  s_lshl_b32 s45, s34, 5
  s_add_u32 s44, s44, s45
  s_lshl_b32 s44, s44, 12
  s_lshl_b32 s45, s35, 11
  s_add_u32 s44, s44, s45
  s_add_u32 s48, s44, 2097152
  s_lshl_b32 s50, s34, 13
  s_add_u32 s50, s50, s45
  s_mov_b32 s8, s76
  s_and_b32 s9, s77, 0xffff
  s_mov_b32 s10, 0x188000
  s_mov_b32 s11, 0x00020000
  s_mov_b32 s12, s68
  s_and_b32 s13, s69, 0xffff
  s_mov_b32 s14, 0x62000
  s_mov_b32 s15, 0x00020000
  v_lshrrev_b32 v165, 3, v1
  v_mul_u32_u24 v6, 896, v165
  v_bfe_u32 v165, v1, 4, 1
  v_lshlrev_b32 v165, 2, v165
  v_and_b32 v166, 7, v1
  v_xor_b32 v166, v166, v165
  v_lshlrev_b32 v166, 4, v166
  v_add_u32 v6, v6, v166
  v_add_u32 v7, 13312, v6
  v_add_u32 v8, 26624, v6
  v_add_u32 v9, 39936, v6
  s_mul_i32 s56, s39, 448
  s_lshl_b32 s44, s38, 3
  s_add_u32 s56, s56, s44
  s_mul_i32 s56, s56, 896
  s_lshl_b32 s45, s37, 7
  s_add_u32 s56, s56, s45
  s_mul_i32 s57, s39, 112
  s_add_u32 s57, s57, s44
  s_mul_i32 s57, s57, 896
  s_add_u32 s57, s57, s45
  s_lshl_b32 s58, s26, 12
  s_lshl_b32 s44, s26, 11
  v_add_u32 v11, s44, v4
  s_xor_b32 s44, s44, 8192
  v_add_u32 v12, s44, v4
  s_lshl_b32 s44, s26, 8
  v_lshlrev_b32 v165, 2, v1
  v_add_u32 v13, s44, v165
  s_xor_b32 s44, s44, 1024
  v_add_u32 v14, s44, v165
  v_and_b32 v15, 7, v1
  v_lshlrev_b32 v15, 2, v15
  s_lshl_b32 s54, s26, 2
  s_add_u32 s54, s54, 20480
  s_lshl_b32 s44, s33, 2
  s_add_u32 s44, s44, s35
  s_lshl_b32 s44, s44, 4
  s_add_u32 s44, s44, s32
  s_lshl_b32 s44, s44, 11
  s_lshl_b32 s45, s34, 10
  s_add_u32 s44, s44, s45
  s_add_u32 s63, s44, 14680064
  s_waitcnt vmcnt(8)
L_attn:
  s_mov_b32 s52, 0
  v_mov_b32 v16, v156
  v_mov_b32 v17, v157
  v_mov_b32 v18, v158
  v_mov_b32 v19, v159
  v_mov_b32 v20, v160
  v_mov_b32 v21, v161
  v_mov_b32 v22, v162
  v_mov_b32 v23, v163
  v_cndmask_b32 v22, v22, 0, s[42:43]
  s_barrier
  ds_read_b128 v[24:27], v4
  ds_read_b128 v[28:31], v4 offset:1024
  ds_read_b128 v[60:63], v2
  ds_read_b128 v[64:67], v2 offset:1024
  ds_read_b64_tr_b16 v[36:37], v3 offset:256
  ds_read_b64_tr_b16 v[38:39], v10 offset:256
  ds_read_b64_tr_b16 v[32:33], v3 offset:0
  ds_read_b64_tr_b16 v[34:35], v10 offset:0
  v_mov_b32 v84, 0
  v_mov_b32 v85, 0
  v_mov_b32 v86, 0
  v_mov_b32 v87, 0
  v_mov_b32 v88, 0
  v_mov_b32 v89, 0
  v_mov_b32 v90, 0
  v_mov_b32 v91, 0
  v_mov_b32 v92, 0
  v_mov_b32 v93, 0
  v_mov_b32 v94, 0
  v_mov_b32 v95, 0
  v_mov_b32 v96, 0
  v_mov_b32 v97, 0
  v_mov_b32 v98, 0
  v_mov_b32 v99, 0
  v_mov_b32 v80, 0
  v_mov_b32 v40, 0
  v_mov_b32 v81, 0
  v_mov_b32 v41, 0
  v_mov_b32 v82, 0
  v_mov_b32 v42, 0
  v_mov_b32 v83, 0
  v_mov_b32 v43, 0
  s_waitcnt lgkmcnt(6)
  v_mfma_f32_32x32x16_bf16 v[44:59], v[24:27], v[16:19], 0
  v_mfma_f32_32x32x16_bf16 v[44:59], v[28:31], v[20:23], v[44:59]
  s_nop 11
  v_max3_f32 v100, v44, v45, v46
  v_max3_f32 v100, v100, v47, v48
  v_max3_f32 v100, v100, v49, v50
  v_max3_f32 v100, v100, v51, v52
  v_max3_f32 v100, v100, v53, v54
  v_max3_f32 v100, v100, v55, v56
  v_max3_f32 v100, v100, v57, v58
  v_max_f32 v104, v100, v59
  v_mov_b32 v100, v104
  v_mov_b32 v101, v104
  s_nop 1
  v_permlane32_swap_b32 v100, v101
  v_max_f32 v104, v100, v101
  v_add_f32 v100, 0x42b40000, v104
  v_sub_f32 v100, 0, v100
  v_cvt_pk_bf16_f32 v101, v100, v100
  v_lshlrev_b32 v101, 16, v101
  v_sub_f32 v102, v100, v101
  v_cvt_pk_bf16_f32 v101, v101, v102
  s_mov_b64 exec, s[42:43]
  v_mov_b32 v22, v101
  s_mov_b64 exec, -1
  s_branch L_att_go
L_att_main:
  ds_read_b128 v[60:63], v2
  ds_read_b128 v[64:67], v2 offset:1024
  ds_read_b64_tr_b16 v[36:37], v3 offset:256
  ds_read_b64_tr_b16 v[38:39], v10 offset:256
  ds_read_b64_tr_b16 v[32:33], v3 offset:0
  ds_read_b64_tr_b16 v[34:35], v10 offset:0
  v_mov_b32 v84, 0
  v_mov_b32 v85, 0
  v_mov_b32 v86, 0
  v_mov_b32 v87, 0
  v_mov_b32 v88, 0
  v_mov_b32 v89, 0
  v_mov_b32 v90, 0
  v_mov_b32 v91, 0
  v_mov_b32 v92, 0
  v_mov_b32 v93, 0
  v_mov_b32 v94, 0
  v_mov_b32 v95, 0
  v_mov_b32 v96, 0
  v_mov_b32 v97, 0
  v_mov_b32 v98, 0
  v_mov_b32 v99, 0
  v_mov_b32 v80, 0
  v_mov_b32 v40, 0
  v_mov_b32 v81, 0
  v_mov_b32 v41, 0
  v_mov_b32 v82, 0
  v_mov_b32 v42, 0
  v_mov_b32 v83, 0
  v_mov_b32 v43, 0
L_att_go:
  s_waitcnt lgkmcnt(0)
  v_mfma_f32_32x32x16_bf16 v[44:59], v[60:63], v[16:19], 0
  v_mfma_f32_32x32x16_bf16 v[44:59], v[64:67], v[20:23], v[44:59]
  ds_read_b128 v[24:27], v2 offset:4096
  ds_read_b128 v[28:31], v2 offset:5120
  s_add_u32 s49, s48, 24576
  s_nop 7
  s_lshl_b32 s55, s36, 1
  s_add_u32 s55, s55, s38
  s_mul_i32 s55, s55, 56
  s_mul_i32 s44, s39, 14
  s_add_u32 s55, s55, s44
  s_lshl_b32 s55, s55, 11
  s_add_u32 s55, s55, 6291456
  s_setprio 3
  s_waitcnt lgkmcnt(0)
  v_mfma_f32_32x32x16_bf16 v[60:75], v[24:27], v[16:19], 0
  s_add_u32 m0, s50, 49152
  v_exp_f32 v44, v44
  v_exp_f32 v45, v45
  v_exp_f32 v46, v46
  v_exp_f32 v47, v47
  v_mfma_f32_32x32x16_bf16 v[60:75], v[28:31], v[20:23], v[60:75]
  s_waitcnt vmcnt(4)
  s_barrier
  ds_read_b128 v[24:27], v2 offset:16384
  ds_read_b128 v[28:31], v2 offset:17408
  v_exp_f32 v48, v48
  v_cvt_pk_bf16_f32 v76, v44, v45
  v_exp_f32 v49, v49
  v_cvt_pk_bf16_f32 v77, v46, v47
  v_exp_f32 v50, v50
  v_exp_f32 v51, v51
  s_setprio 2
  v_mfma_f32_32x32x16_bf16 v[84:99], v[40:43], v[80:83], v[84:99]
  buffer_load_dwordx4 v4, s[16:19], s49 offen sc1 lds
  s_add_u32 m0, s50, 50176
  ds_read_b64_tr_b16 v[40:41], v3 offset:4352
  ds_read_b64_tr_b16 v[42:43], v10 offset:4352
  v_exp_f32 v52, v52
  v_cvt_pk_bf16_f32 v78, v48, v49
  v_exp_f32 v53, v53
  v_cvt_pk_bf16_f32 v79, v50, v51
  v_exp_f32 v54, v54
  v_exp_f32 v55, v55
  v_mfma_f32_32x32x16_bf16 v[84:99], v[32:35], v[76:79], v[84:99]
  buffer_load_dwordx4 v5, s[16:19], s49 offen sc1 lds
  s_add_u32 s49, s49, 8192
  ds_read_b64_tr_b16 v[32:33], v3 offset:4096
  ds_read_b64_tr_b16 v[34:35], v10 offset:4096
  v_exp_f32 v56, v56
  v_cvt_pk_bf16_f32 v80, v52, v53
  v_exp_f32 v57, v57
  v_cvt_pk_bf16_f32 v81, v54, v55
  v_exp_f32 v58, v58
  v_exp_f32 v59, v59
  v_cvt_pk_bf16_f32 v82, v56, v57
  v_cvt_pk_bf16_f32 v83, v58, v59
  s_setprio 1
  s_waitcnt lgkmcnt(4)
  v_mfma_f32_32x32x16_bf16 v[44:59], v[24:27], v[16:19], 0
  s_add_u32 m0, s58, 65536
  s_add_u32 s59, s56, 0
  buffer_load_dwordx4 v6, s[8:11], s59 offen lds
  v_exp_f32 v60, v60
  v_exp_f32 v61, v61
  v_exp_f32 v62, v62
  v_exp_f32 v63, v63
  v_mfma_f32_32x32x16_bf16 v[44:59], v[28:31], v[20:23], v[44:59]
  buffer_load_dwordx4 v7, s[8:11], s59 offen offset:1024 lds
  ds_read_b128 v[24:27], v2 offset:20480
  ds_read_b128 v[28:31], v2 offset:21504
  v_exp_f32 v64, v64
  v_cvt_pk_bf16_f32 v76, v60, v61
  v_exp_f32 v65, v65
  v_cvt_pk_bf16_f32 v77, v62, v63
  v_exp_f32 v66, v66
  v_exp_f32 v67, v67
  s_setprio 0
  v_mfma_f32_32x32x16_bf16 v[84:99], v[36:39], v[80:83], v[84:99]
  buffer_load_dwordx4 v8, s[8:11], s59 offen offset:2048 lds
  ds_read_b64_tr_b16 v[36:37], v3 offset:16640
  ds_read_b64_tr_b16 v[38:39], v10 offset:16640
  v_exp_f32 v68, v68
  v_cvt_pk_bf16_f32 v78, v64, v65
  v_exp_f32 v69, v69
  v_cvt_pk_bf16_f32 v79, v66, v67
  v_exp_f32 v70, v70
  v_exp_f32 v71, v71
  s_waitcnt lgkmcnt(4)
  v_mfma_f32_32x32x16_bf16 v[84:99], v[32:35], v[76:79], v[84:99]
  buffer_load_dwordx4 v9, s[8:11], s59 offen offset:3072 lds
  ds_read_b64_tr_b16 v[32:33], v3 offset:16384
  ds_read_b64_tr_b16 v[34:35], v10 offset:16384
  v_exp_f32 v72, v72
  v_cvt_pk_bf16_f32 v80, v68, v69
  v_exp_f32 v73, v73
  v_cvt_pk_bf16_f32 v81, v70, v71
  v_exp_f32 v74, v74
  v_exp_f32 v75, v75
  v_cvt_pk_bf16_f32 v82, v72, v73
  v_cvt_pk_bf16_f32 v83, v74, v75
  s_setprio 3
  s_waitcnt lgkmcnt(4)
  v_mfma_f32_32x32x16_bf16 v[60:75], v[24:27], v[16:19], 0
  s_add_u32 m0, s50, 0
  v_exp_f32 v44, v44
  v_exp_f32 v45, v45
  v_exp_f32 v46, v46
  v_exp_f32 v47, v47
  v_mfma_f32_32x32x16_bf16 v[60:75], v[28:31], v[20:23], v[60:75]
  s_waitcnt vmcnt(6)
  s_barrier
  ds_read_b128 v[24:27], v2 offset:32768
  ds_read_b128 v[28:31], v2 offset:33792
  v_exp_f32 v48, v48
  v_cvt_pk_bf16_f32 v76, v44, v45
  v_exp_f32 v49, v49
  v_cvt_pk_bf16_f32 v77, v46, v47
  v_exp_f32 v50, v50
  v_exp_f32 v51, v51
  s_setprio 2
  v_mfma_f32_32x32x16_bf16 v[84:99], v[40:43], v[80:83], v[84:99]
  buffer_load_dwordx4 v4, s[16:19], s49 offen sc1 lds
  s_add_u32 m0, s50, 1024
  ds_read_b64_tr_b16 v[40:41], v3 offset:20736
  ds_read_b64_tr_b16 v[42:43], v10 offset:20736
  v_exp_f32 v52, v52
  v_cvt_pk_bf16_f32 v78, v48, v49
  v_exp_f32 v53, v53
  v_cvt_pk_bf16_f32 v79, v50, v51
  v_exp_f32 v54, v54
  v_exp_f32 v55, v55
  s_waitcnt lgkmcnt(4)
  v_mfma_f32_32x32x16_bf16 v[84:99], v[32:35], v[76:79], v[84:99]
  buffer_load_dwordx4 v5, s[16:19], s49 offen sc1 lds
  s_add_u32 s49, s49, 8192
  ds_read_b64_tr_b16 v[32:33], v3 offset:20480
  ds_read_b64_tr_b16 v[34:35], v10 offset:20480
  v_exp_f32 v56, v56
  v_cvt_pk_bf16_f32 v80, v52, v53
  v_exp_f32 v57, v57
  v_cvt_pk_bf16_f32 v81, v54, v55
  v_exp_f32 v58, v58
  v_exp_f32 v59, v59
  v_cvt_pk_bf16_f32 v82, v56, v57
  v_cvt_pk_bf16_f32 v83, v58, v59
  s_setprio 1
  s_waitcnt lgkmcnt(4)
  v_mfma_f32_32x32x16_bf16 v[44:59], v[24:27], v[16:19], 0
  s_add_u32 m0, s58, 98304
  s_add_u32 s59, s56, 57344
  buffer_load_dwordx4 v6, s[8:11], s59 offen lds
  v_exp_f32 v60, v60
  v_exp_f32 v61, v61
  v_exp_f32 v62, v62
  v_exp_f32 v63, v63
  v_mfma_f32_32x32x16_bf16 v[44:59], v[28:31], v[20:23], v[44:59]
  buffer_load_dwordx4 v7, s[8:11], s59 offen offset:1024 lds
  ds_read_b128 v[24:27], v2 offset:36864
  ds_read_b128 v[28:31], v2 offset:37888
  v_exp_f32 v64, v64
  v_cvt_pk_bf16_f32 v76, v60, v61
  v_exp_f32 v65, v65
  v_cvt_pk_bf16_f32 v77, v62, v63
  v_exp_f32 v66, v66
  v_exp_f32 v67, v67
  s_setprio 0
  v_mfma_f32_32x32x16_bf16 v[84:99], v[36:39], v[80:83], v[84:99]
  buffer_load_dwordx4 v8, s[8:11], s59 offen offset:2048 lds
  ds_read_b64_tr_b16 v[36:37], v3 offset:33024
  ds_read_b64_tr_b16 v[38:39], v10 offset:33024
  v_exp_f32 v68, v68
  v_cvt_pk_bf16_f32 v78, v64, v65
  v_exp_f32 v69, v69
  v_cvt_pk_bf16_f32 v79, v66, v67
  v_exp_f32 v70, v70
  v_exp_f32 v71, v71
  s_waitcnt lgkmcnt(4)
  v_mfma_f32_32x32x16_bf16 v[84:99], v[32:35], v[76:79], v[84:99]
  buffer_load_dwordx4 v9, s[8:11], s59 offen offset:3072 lds
  ds_read_b64_tr_b16 v[32:33], v3 offset:32768
  ds_read_b64_tr_b16 v[34:35], v10 offset:32768
  v_exp_f32 v72, v72
  v_cvt_pk_bf16_f32 v80, v68, v69
  v_exp_f32 v73, v73
  v_cvt_pk_bf16_f32 v81, v70, v71
  v_exp_f32 v74, v74
  v_exp_f32 v75, v75
  v_cvt_pk_bf16_f32 v82, v72, v73
  v_cvt_pk_bf16_f32 v83, v74, v75
  s_setprio 3
  s_waitcnt lgkmcnt(4)
  v_mfma_f32_32x32x16_bf16 v[60:75], v[24:27], v[16:19], 0
  s_add_u32 m0, s50, 16384
  v_exp_f32 v44, v44
  v_exp_f32 v45, v45
  v_exp_f32 v46, v46
  v_exp_f32 v47, v47
  v_mfma_f32_32x32x16_bf16 v[60:75], v[28:31], v[20:23], v[60:75]
  s_waitcnt vmcnt(10)
  s_barrier
  s_cmp_lg_u32 s26, 4
  s_cbranch_scc1 L_only_37
  s_lshl_b32 s44, s24, 7
  s_lshl_b32 s45, s25, 2
  s_add_u32 s44, s44, s45
  s_add_u32 s44, s44, 16781312
  v_mov_b32 v100, s61
  v_mov_b32 v101, 0
  s_mov_b64 exec, 1
  buffer_store_dword v100, v101, s[16:19], s44 offen sc1
  s_mov_b64 exec, -1
L_only_37:
  ds_read_b128 v[24:27], v2 offset:49152
  ds_read_b128 v[28:31], v2 offset:50176
  v_exp_f32 v48, v48
  v_cvt_pk_bf16_f32 v76, v44, v45
  v_exp_f32 v49, v49
  v_cvt_pk_bf16_f32 v77, v46, v47
  v_exp_f32 v50, v50
  v_exp_f32 v51, v51
  s_setprio 2
  v_mfma_f32_32x32x16_bf16 v[84:99], v[40:43], v[80:83], v[84:99]
  buffer_load_dwordx4 v4, s[16:19], s49 offen sc1 lds
  s_add_u32 m0, s50, 17408
  ds_read_b64_tr_b16 v[40:41], v3 offset:37120
  ds_read_b64_tr_b16 v[42:43], v10 offset:37120
  v_exp_f32 v52, v52
  v_cvt_pk_bf16_f32 v78, v48, v49
  v_exp_f32 v53, v53
  v_cvt_pk_bf16_f32 v79, v50, v51
  v_exp_f32 v54, v54
  v_exp_f32 v55, v55
  s_waitcnt lgkmcnt(4)
  v_mfma_f32_32x32x16_bf16 v[84:99], v[32:35], v[76:79], v[84:99]
  buffer_load_dwordx4 v5, s[16:19], s49 offen sc1 lds
  s_add_u32 s49, s49, 8192
  ds_read_b64_tr_b16 v[32:33], v3 offset:36864
  ds_read_b64_tr_b16 v[34:35], v10 offset:36864
  v_exp_f32 v56, v56
  v_cvt_pk_bf16_f32 v80, v52, v53
  v_exp_f32 v57, v57
  v_cvt_pk_bf16_f32 v81, v54, v55
  v_exp_f32 v58, v58
  v_exp_f32 v59, v59
  v_cvt_pk_bf16_f32 v82, v56, v57
  v_cvt_pk_bf16_f32 v83, v58, v59
  s_setprio 1
  s_waitcnt lgkmcnt(4)
  v_mfma_f32_32x32x16_bf16 v[44:59], v[24:27], v[16:19], 0
  s_add_u32 m0, s58, 131072
  s_add_u32 s59, s56, 114688
  buffer_load_dwordx4 v6, s[8:11], s59 offen lds
  v_exp_f32 v60, v60
  v_exp_f32 v61, v61
  v_exp_f32 v62, v62
  v_exp_f32 v63, v63
  v_mfma_f32_32x32x16_bf16 v[44:59], v[28:31], v[20:23], v[44:59]
  buffer_load_dwordx4 v7, s[8:11], s59 offen offset:1024 lds
  ds_read_b128 v[24:27], v2 offset:53248
  ds_read_b128 v[28:31], v2 offset:54272
  v_exp_f32 v64, v64
  v_cvt_pk_bf16_f32 v76, v60, v61
  v_exp_f32 v65, v65
  v_cvt_pk_bf16_f32 v77, v62, v63
  v_exp_f32 v66, v66
  v_exp_f32 v67, v67
  s_setprio 0
  v_mfma_f32_32x32x16_bf16 v[84:99], v[36:39], v[80:83], v[84:99]
  buffer_load_dwordx4 v8, s[8:11], s59 offen offset:2048 lds
  ds_read_b64_tr_b16 v[36:37], v3 offset:49408
  ds_read_b64_tr_b16 v[38:39], v10 offset:49408
  v_exp_f32 v68, v68
  v_cvt_pk_bf16_f32 v78, v64, v65
  v_exp_f32 v69, v69
  v_cvt_pk_bf16_f32 v79, v66, v67
  v_exp_f32 v70, v70
  v_exp_f32 v71, v71
  s_waitcnt lgkmcnt(4)
  v_mfma_f32_32x32x16_bf16 v[84:99], v[32:35], v[76:79], v[84:99]
  buffer_load_dwordx4 v9, s[8:11], s59 offen offset:3072 lds
  ds_read_b64_tr_b16 v[32:33], v3 offset:49152
  ds_read_b64_tr_b16 v[34:35], v10 offset:49152
  v_exp_f32 v72, v72
  v_cvt_pk_bf16_f32 v80, v68, v69
  v_exp_f32 v73, v73
  v_cvt_pk_bf16_f32 v81, v70, v71
  v_exp_f32 v74, v74
  v_exp_f32 v75, v75
  v_cvt_pk_bf16_f32 v82, v72, v73
  v_cvt_pk_bf16_f32 v83, v74, v75
  s_setprio 3
  s_waitcnt lgkmcnt(4)
  v_mfma_f32_32x32x16_bf16 v[60:75], v[24:27], v[16:19], 0
  s_add_u32 m0, s50, 32768
  v_exp_f32 v44, v44
  v_exp_f32 v45, v45
  v_exp_f32 v46, v46
  v_exp_f32 v47, v47
  v_mfma_f32_32x32x16_bf16 v[60:75], v[28:31], v[20:23], v[60:75]
  s_waitcnt vmcnt(10)
  s_barrier
  ds_read_b128 v[24:27], v2 offset:0
  ds_read_b128 v[28:31], v2 offset:1024
  v_exp_f32 v48, v48
  v_cvt_pk_bf16_f32 v76, v44, v45
  v_exp_f32 v49, v49
  v_cvt_pk_bf16_f32 v77, v46, v47
  v_exp_f32 v50, v50
  v_exp_f32 v51, v51
  s_setprio 2
  v_mfma_f32_32x32x16_bf16 v[84:99], v[40:43], v[80:83], v[84:99]
  buffer_load_dwordx4 v4, s[16:19], s49 offen sc1 lds
  s_add_u32 m0, s50, 33792
  ds_read_b64_tr_b16 v[40:41], v3 offset:53504
  ds_read_b64_tr_b16 v[42:43], v10 offset:53504
  v_exp_f32 v52, v52
  v_cvt_pk_bf16_f32 v78, v48, v49
  v_exp_f32 v53, v53
  v_cvt_pk_bf16_f32 v79, v50, v51
  v_exp_f32 v54, v54
  v_exp_f32 v55, v55
  s_waitcnt lgkmcnt(4)
  v_mfma_f32_32x32x16_bf16 v[84:99], v[32:35], v[76:79], v[84:99]
  buffer_load_dwordx4 v5, s[16:19], s49 offen sc1 lds
  s_add_u32 s49, s49, 8192
  ds_read_b64_tr_b16 v[32:33], v3 offset:53248
  ds_read_b64_tr_b16 v[34:35], v10 offset:53248
  v_exp_f32 v56, v56
  v_cvt_pk_bf16_f32 v80, v52, v53
  v_exp_f32 v57, v57
  v_cvt_pk_bf16_f32 v81, v54, v55
  v_exp_f32 v58, v58
  v_exp_f32 v59, v59
  v_cvt_pk_bf16_f32 v82, v56, v57
  v_cvt_pk_bf16_f32 v83, v58, v59
  s_setprio 1
  s_waitcnt lgkmcnt(4)
  v_mfma_f32_32x32x16_bf16 v[44:59], v[24:27], v[16:19], 0
  v_exp_f32 v60, v60
  v_exp_f32 v61, v61
  v_exp_f32 v62, v62
  v_exp_f32 v63, v63
  v_mfma_f32_32x32x16_bf16 v[44:59], v[28:31], v[20:23], v[44:59]
  s_cmp_lg_u32 s26, 4
  s_cbranch_scc1 L_only_38
  v_min_u32 v100, 13, v1
  v_lshlrev_b32 v100, 2, v100
  s_lshr_b32 s44, s36, 1
  s_lshl_b32 s44, s44, 7
  s_add_u32 s44, s44, 16781312
  v_add_u32 v100, s44, v100
  s_mov_b32 s62, 0x10000
L_poll_h_39:
  buffer_load_dword v101, v100, s[16:19], 0 offen sc1
  s_waitcnt vmcnt(0)
  v_cmp_ne_u32 vcc, s61, v101
  s_nop 0
  s_cbranch_vccz L_polld_h_40
  s_sub_u32 s62, s62, 1
  s_cmp_eq_u32 s62, 0
  s_cbranch_scc1 L_polld_h_40
  s_sleep 1
  s_branch L_poll_h_39
L_polld_h_40:
L_only_38:
  ds_read_b128 v[24:27], v2 offset:4096
  ds_read_b128 v[28:31], v2 offset:5120
  v_exp_f32 v64, v64
  v_cvt_pk_bf16_f32 v76, v60, v61
  v_exp_f32 v65, v65
  v_cvt_pk_bf16_f32 v77, v62, v63
  v_exp_f32 v66, v66
  v_exp_f32 v67, v67
  s_setprio 0
  v_mfma_f32_32x32x16_bf16 v[84:99], v[36:39], v[80:83], v[84:99]
  ds_read_b64_tr_b16 v[36:37], v3 offset:256
  ds_read_b64_tr_b16 v[38:39], v10 offset:256
  v_exp_f32 v68, v68
  v_cvt_pk_bf16_f32 v78, v64, v65
  v_exp_f32 v69, v69
  v_cvt_pk_bf16_f32 v79, v66, v67
  v_exp_f32 v70, v70
  v_exp_f32 v71, v71
  s_waitcnt lgkmcnt(4)
  v_mfma_f32_32x32x16_bf16 v[84:99], v[32:35], v[76:79], v[84:99]
  ds_read_b64_tr_b16 v[32:33], v3 offset:0
  ds_read_b64_tr_b16 v[34:35], v10 offset:0
  v_exp_f32 v72, v72
  v_cvt_pk_bf16_f32 v80, v68, v69
  v_exp_f32 v73, v73
  v_cvt_pk_bf16_f32 v81, v70, v71
  v_exp_f32 v74, v74
  v_exp_f32 v75, v75
  v_cvt_pk_bf16_f32 v82, v72, v73
  v_cvt_pk_bf16_f32 v83, v74, v75
  s_setprio 3
  s_waitcnt lgkmcnt(4)
  v_mfma_f32_32x32x16_bf16 v[60:75], v[24:27], v[16:19], 0
  s_add_u32 m0, s50, 49152
  v_exp_f32 v44, v44
  v_exp_f32 v45, v45
  v_exp_f32 v46, v46
  v_exp_f32 v47, v47
  v_mfma_f32_32x32x16_bf16 v[60:75], v[28:31], v[20:23], v[60:75]
  s_waitcnt vmcnt(6)
  s_barrier
  ds_read_b128 v[24:27], v2 offset:16384
  ds_read_b128 v[28:31], v2 offset:17408
  v_exp_f32 v48, v48
  v_cvt_pk_bf16_f32 v76, v44, v45
  v_exp_f32 v49, v49
  v_cvt_pk_bf16_f32 v77, v46, v47
  v_exp_f32 v50, v50
  v_exp_f32 v51, v51
  s_setprio 2
  v_mfma_f32_32x32x16_bf16 v[84:99], v[40:43], v[80:83], v[84:99]
  buffer_load_dwordx4 v4, s[16:19], s49 offen sc1 lds
  s_add_u32 m0, s50, 50176
  ds_read_b64_tr_b16 v[40:41], v3 offset:4352
  ds_read_b64_tr_b16 v[42:43], v10 offset:4352
  v_exp_f32 v52, v52
  v_cvt_pk_bf16_f32 v78, v48, v49
  v_exp_f32 v53, v53
  v_cvt_pk_bf16_f32 v79, v50, v51
  v_exp_f32 v54, v54
  v_exp_f32 v55, v55
  s_waitcnt lgkmcnt(4)
  v_mfma_f32_32x32x16_bf16 v[84:99], v[32:35], v[76:79], v[84:99]
  buffer_load_dwordx4 v5, s[16:19], s49 offen sc1 lds
  s_add_u32 s49, s49, 8192
  ds_read_b64_tr_b16 v[32:33], v3 offset:4096
  ds_read_b64_tr_b16 v[34:35], v10 offset:4096
  v_exp_f32 v56, v56
  v_cvt_pk_bf16_f32 v80, v52, v53
  v_exp_f32 v57, v57
  v_cvt_pk_bf16_f32 v81, v54, v55
  v_exp_f32 v58, v58
  v_exp_f32 v59, v59
  v_cvt_pk_bf16_f32 v82, v56, v57
  v_cvt_pk_bf16_f32 v83, v58, v59
  s_setprio 1
  s_waitcnt lgkmcnt(4)
  v_mfma_f32_32x32x16_bf16 v[44:59], v[24:27], v[16:19], 0
  v_exp_f32 v60, v60
  v_exp_f32 v61, v61
  v_exp_f32 v62, v62
  v_exp_f32 v63, v63
  v_mfma_f32_32x32x16_bf16 v[44:59], v[28:31], v[20:23], v[44:59]
  ds_read_b128 v[24:27], v2 offset:20480
  ds_read_b128 v[28:31], v2 offset:21504
  v_exp_f32 v64, v64
  v_cvt_pk_bf16_f32 v76, v60, v61
  v_exp_f32 v65, v65
  v_cvt_pk_bf16_f32 v77, v62, v63
  v_exp_f32 v66, v66
  v_exp_f32 v67, v67
  s_setprio 0
  v_mfma_f32_32x32x16_bf16 v[84:99], v[36:39], v[80:83], v[84:99]
  ds_read_b64_tr_b16 v[36:37], v3 offset:16640
  ds_read_b64_tr_b16 v[38:39], v10 offset:16640
  v_exp_f32 v68, v68
  v_cvt_pk_bf16_f32 v78, v64, v65
  v_exp_f32 v69, v69
  v_cvt_pk_bf16_f32 v79, v66, v67
  v_exp_f32 v70, v70
  v_exp_f32 v71, v71
  s_waitcnt lgkmcnt(4)
  v_mfma_f32_32x32x16_bf16 v[84:99], v[32:35], v[76:79], v[84:99]
  ds_read_b64_tr_b16 v[32:33], v3 offset:16384
  ds_read_b64_tr_b16 v[34:35], v10 offset:16384
  v_exp_f32 v72, v72
  v_cvt_pk_bf16_f32 v80, v68, v69
  v_exp_f32 v73, v73
  v_cvt_pk_bf16_f32 v81, v70, v71
  v_exp_f32 v74, v74
  v_exp_f32 v75, v75
  v_cvt_pk_bf16_f32 v82, v72, v73
  v_cvt_pk_bf16_f32 v83, v74, v75
  s_setprio 3
  s_waitcnt lgkmcnt(4)
  v_mfma_f32_32x32x16_bf16 v[60:75], v[24:27], v[16:19], 0
  s_add_u32 m0, s50, 0
  v_exp_f32 v44, v44
  v_exp_f32 v45, v45
  v_exp_f32 v46, v46
  v_exp_f32 v47, v47
  v_mfma_f32_32x32x16_bf16 v[60:75], v[28:31], v[20:23], v[60:75]
  s_waitcnt vmcnt(2)
  s_barrier
  ds_read_b128 v[24:27], v2 offset:32768
  ds_read_b128 v[28:31], v2 offset:33792
  v_exp_f32 v48, v48
  v_cvt_pk_bf16_f32 v76, v44, v45
  v_exp_f32 v49, v49
  v_cvt_pk_bf16_f32 v77, v46, v47
  v_exp_f32 v50, v50
  v_exp_f32 v51, v51
  s_setprio 2
  v_mfma_f32_32x32x16_bf16 v[84:99], v[40:43], v[80:83], v[84:99]
  buffer_load_dwordx4 v4, s[16:19], s49 offen sc1 lds
  s_add_u32 m0, s50, 1024
  ds_read_b64_tr_b16 v[40:41], v3 offset:20736
  ds_read_b64_tr_b16 v[42:43], v10 offset:20736
  v_exp_f32 v52, v52
  v_cvt_pk_bf16_f32 v78, v48, v49
  v_exp_f32 v53, v53
  v_cvt_pk_bf16_f32 v79, v50, v51
  v_exp_f32 v54, v54
  v_exp_f32 v55, v55
  s_waitcnt lgkmcnt(4)
  v_mfma_f32_32x32x16_bf16 v[84:99], v[32:35], v[76:79], v[84:99]
  buffer_load_dwordx4 v5, s[16:19], s49 offen sc1 lds
  s_add_u32 s49, s49, 8192
  ds_read_b64_tr_b16 v[32:33], v3 offset:20480
  ds_read_b64_tr_b16 v[34:35], v10 offset:20480
  v_exp_f32 v56, v56
  v_cvt_pk_bf16_f32 v80, v52, v53
  v_exp_f32 v57, v57
  v_cvt_pk_bf16_f32 v81, v54, v55
  v_exp_f32 v58, v58
  v_exp_f32 v59, v59
  v_cvt_pk_bf16_f32 v82, v56, v57
  v_cvt_pk_bf16_f32 v83, v58, v59
  s_setprio 1
  s_waitcnt lgkmcnt(4)
  v_mfma_f32_32x32x16_bf16 v[44:59], v[24:27], v[16:19], 0
  s_nop 0
  buffer_load_dwordx4 v[144:147], v4, s[16:19], s55 offen offset:0 sc1
  v_exp_f32 v60, v60
  v_exp_f32 v61, v61
  v_exp_f32 v62, v62
  v_exp_f32 v63, v63
  v_mfma_f32_32x32x16_bf16 v[44:59], v[28:31], v[20:23], v[44:59]
  buffer_load_dwordx4 v[148:151], v4, s[16:19], s55 offen offset:1024 sc1
  ds_read_b128 v[24:27], v2 offset:36864
  ds_read_b128 v[28:31], v2 offset:37888
  v_exp_f32 v64, v64
  v_cvt_pk_bf16_f32 v76, v60, v61
  v_exp_f32 v65, v65
  v_cvt_pk_bf16_f32 v77, v62, v63
  v_exp_f32 v66, v66
  v_exp_f32 v67, v67
  s_setprio 0
  v_mfma_f32_32x32x16_bf16 v[84:99], v[36:39], v[80:83], v[84:99]
  buffer_load_dwordx4 v[152:155], v4, s[16:19], s55 offen offset:2048 sc1
  ds_read_b64_tr_b16 v[36:37], v3 offset:33024
  ds_read_b64_tr_b16 v[38:39], v10 offset:33024
  v_exp_f32 v68, v68
  v_cvt_pk_bf16_f32 v78, v64, v65
  v_exp_f32 v69, v69
  v_cvt_pk_bf16_f32 v79, v66, v67
  v_exp_f32 v70, v70
  v_exp_f32 v71, v71
  s_waitcnt lgkmcnt(4)
  v_mfma_f32_32x32x16_bf16 v[84:99], v[32:35], v[76:79], v[84:99]
  ds_read_b64_tr_b16 v[32:33], v3 offset:32768
  ds_read_b64_tr_b16 v[34:35], v10 offset:32768
  v_exp_f32 v72, v72
  v_cvt_pk_bf16_f32 v80, v68, v69
  v_exp_f32 v73, v73
  v_cvt_pk_bf16_f32 v81, v70, v71
  v_exp_f32 v74, v74
  v_exp_f32 v75, v75
  v_cvt_pk_bf16_f32 v82, v72, v73
  v_cvt_pk_bf16_f32 v83, v74, v75
  s_setprio 3
  s_waitcnt lgkmcnt(4)
  v_mfma_f32_32x32x16_bf16 v[60:75], v[24:27], v[16:19], 0
  s_add_u32 m0, s50, 16384
  v_exp_f32 v44, v44
  v_exp_f32 v45, v45
  v_exp_f32 v46, v46
  v_exp_f32 v47, v47
  v_mfma_f32_32x32x16_bf16 v[60:75], v[28:31], v[20:23], v[60:75]
  s_waitcnt vmcnt(5)
  s_barrier
  ds_read_b128 v[24:27], v2 offset:49152
  ds_read_b128 v[28:31], v2 offset:50176
  v_exp_f32 v48, v48
  v_cvt_pk_bf16_f32 v76, v44, v45
  v_exp_f32 v49, v49
  v_cvt_pk_bf16_f32 v77, v46, v47
  v_exp_f32 v50, v50
  v_exp_f32 v51, v51
  s_setprio 2
  v_mfma_f32_32x32x16_bf16 v[84:99], v[40:43], v[80:83], v[84:99]
  buffer_load_dwordx4 v4, s[16:19], s49 offen sc1 lds
  s_add_u32 m0, s50, 17408
  ds_read_b64_tr_b16 v[40:41], v3 offset:37120
  ds_read_b64_tr_b16 v[42:43], v10 offset:37120
  v_exp_f32 v52, v52
  v_cvt_pk_bf16_f32 v78, v48, v49
  v_exp_f32 v53, v53
  v_cvt_pk_bf16_f32 v79, v50, v51
  v_exp_f32 v54, v54
  v_exp_f32 v55, v55
  s_waitcnt lgkmcnt(4)
  v_mfma_f32_32x32x16_bf16 v[84:99], v[32:35], v[76:79], v[84:99]
  buffer_load_dwordx4 v5, s[16:19], s49 offen sc1 lds
  s_add_u32 s49, s49, 8192
  ds_read_b64_tr_b16 v[32:33], v3 offset:36864
  ds_read_b64_tr_b16 v[34:35], v10 offset:36864
  v_exp_f32 v56, v56
  v_cvt_pk_bf16_f32 v80, v52, v53
  v_exp_f32 v57, v57
  v_cvt_pk_bf16_f32 v81, v54, v55
  v_exp_f32 v58, v58
  v_exp_f32 v59, v59
  v_cvt_pk_bf16_f32 v82, v56, v57
  v_cvt_pk_bf16_f32 v83, v58, v59
  s_setprio 1
  s_waitcnt lgkmcnt(4)
  v_mfma_f32_32x32x16_bf16 v[44:59], v[24:27], v[16:19], 0
  buffer_load_dwordx4 v[156:159], v4, s[16:19], s55 offen offset:3072 sc1
  v_exp_f32 v60, v60
  v_exp_f32 v61, v61
  v_exp_f32 v62, v62
  v_exp_f32 v63, v63
  v_mfma_f32_32x32x16_bf16 v[44:59], v[28:31], v[20:23], v[44:59]
  s_add_u32 s55, s55, 4096
  buffer_load_dwordx4 v[160:163], v4, s[16:19], s55 offen offset:0 sc1
  ds_read_b128 v[24:27], v2 offset:53248
  ds_read_b128 v[28:31], v2 offset:54272
  v_exp_f32 v64, v64
  v_cvt_pk_bf16_f32 v76, v60, v61
  v_exp_f32 v65, v65
  v_cvt_pk_bf16_f32 v77, v62, v63
  v_exp_f32 v66, v66
  v_exp_f32 v67, v67
  s_setprio 0
  v_mfma_f32_32x32x16_bf16 v[84:99], v[36:39], v[80:83], v[84:99]
  buffer_load_dwordx4 v[164:167], v4, s[16:19], s55 offen offset:1024 sc1
  ds_read_b64_tr_b16 v[36:37], v3 offset:49408
  ds_read_b64_tr_b16 v[38:39], v10 offset:49408
  v_exp_f32 v68, v68
  v_cvt_pk_bf16_f32 v78, v64, v65
  v_exp_f32 v69, v69
  v_cvt_pk_bf16_f32 v79, v66, v67
  v_exp_f32 v70, v70
  v_exp_f32 v71, v71
  s_waitcnt lgkmcnt(4)
  v_mfma_f32_32x32x16_bf16 v[84:99], v[32:35], v[76:79], v[84:99]
  ds_read_b64_tr_b16 v[32:33], v3 offset:49152
  ds_read_b64_tr_b16 v[34:35], v10 offset:49152
  v_exp_f32 v72, v72
  v_cvt_pk_bf16_f32 v80, v68, v69
  v_exp_f32 v73, v73
  v_cvt_pk_bf16_f32 v81, v70, v71
  v_exp_f32 v74, v74
  v_exp_f32 v75, v75
  v_cvt_pk_bf16_f32 v82, v72, v73
  v_cvt_pk_bf16_f32 v83, v74, v75
  s_setprio 3
  s_waitcnt lgkmcnt(4)
  v_mfma_f32_32x32x16_bf16 v[60:75], v[24:27], v[16:19], 0
  s_add_u32 m0, s50, 32768
  v_exp_f32 v44, v44
  v_exp_f32 v45, v45
  v_exp_f32 v46, v46
  v_exp_f32 v47, v47
  v_mfma_f32_32x32x16_bf16 v[60:75], v[28:31], v[20:23], v[60:75]
  s_waitcnt vmcnt(8)
  s_barrier
  ds_read_b128 v[24:27], v2 offset:0
  ds_read_b128 v[28:31], v2 offset:1024
  v_exp_f32 v48, v48
  v_cvt_pk_bf16_f32 v76, v44, v45
  v_exp_f32 v49, v49
  v_cvt_pk_bf16_f32 v77, v46, v47
  v_exp_f32 v50, v50
  v_exp_f32 v51, v51
  s_setprio 2
  v_mfma_f32_32x32x16_bf16 v[84:99], v[40:43], v[80:83], v[84:99]
  buffer_load_dwordx4 v4, s[16:19], s49 offen sc1 lds
  s_add_u32 m0, s50, 33792
  ds_read_b64_tr_b16 v[40:41], v3 offset:53504
  ds_read_b64_tr_b16 v[42:43], v10 offset:53504
  v_exp_f32 v52, v52
  v_cvt_pk_bf16_f32 v78, v48, v49
  v_exp_f32 v53, v53
  v_cvt_pk_bf16_f32 v79, v50, v51
  v_exp_f32 v54, v54
  v_exp_f32 v55, v55
  s_waitcnt lgkmcnt(4)
  v_mfma_f32_32x32x16_bf16 v[84:99], v[32:35], v[76:79], v[84:99]
  buffer_load_dwordx4 v5, s[16:19], s49 offen sc1 lds
  s_add_u32 s49, s49, 8192
  ds_read_b64_tr_b16 v[32:33], v3 offset:53248
  ds_read_b64_tr_b16 v[34:35], v10 offset:53248
  v_exp_f32 v56, v56
  v_cvt_pk_bf16_f32 v80, v52, v53
  v_exp_f32 v57, v57
  v_cvt_pk_bf16_f32 v81, v54, v55
  v_exp_f32 v58, v58
  v_exp_f32 v59, v59
  v_cvt_pk_bf16_f32 v82, v56, v57
  v_cvt_pk_bf16_f32 v83, v58, v59
  s_setprio 1
  s_waitcnt lgkmcnt(4)
  v_mfma_f32_32x32x16_bf16 v[44:59], v[24:27], v[16:19], 0
  buffer_load_dwordx4 v[168:171], v4, s[16:19], s55 offen offset:2048 sc1
  v_exp_f32 v60, v60
  v_exp_f32 v61, v61
  v_exp_f32 v62, v62
  v_exp_f32 v63, v63
  v_mfma_f32_32x32x16_bf16 v[44:59], v[28:31], v[20:23], v[44:59]
  buffer_load_dwordx4 v[172:175], v4, s[16:19], s55 offen offset:3072 sc1
  ds_read_b128 v[24:27], v2 offset:4096
  ds_read_b128 v[28:31], v2 offset:5120
  v_exp_f32 v64, v64
  v_cvt_pk_bf16_f32 v76, v60, v61
  v_exp_f32 v65, v65
  v_cvt_pk_bf16_f32 v77, v62, v63
  v_exp_f32 v66, v66
  v_exp_f32 v67, v67
  s_setprio 0
  v_mfma_f32_32x32x16_bf16 v[84:99], v[36:39], v[80:83], v[84:99]
  s_add_u32 s55, s55, 4096
  buffer_load_dwordx4 v[176:179], v4, s[16:19], s55 offen offset:0 sc1
  ds_read_b64_tr_b16 v[36:37], v3 offset:256
  ds_read_b64_tr_b16 v[38:39], v10 offset:256
  v_exp_f32 v68, v68
  v_cvt_pk_bf16_f32 v78, v64, v65
  v_exp_f32 v69, v69
  v_cvt_pk_bf16_f32 v79, v66, v67
  v_exp_f32 v70, v70
  v_exp_f32 v71, v71
  s_waitcnt lgkmcnt(4)
  v_mfma_f32_32x32x16_bf16 v[84:99], v[32:35], v[76:79], v[84:99]
  ds_read_b64_tr_b16 v[32:33], v3 offset:0
  ds_read_b64_tr_b16 v[34:35], v10 offset:0
  v_exp_f32 v72, v72
  v_cvt_pk_bf16_f32 v80, v68, v69
  v_exp_f32 v73, v73
  v_cvt_pk_bf16_f32 v81, v70, v71
  v_exp_f32 v74, v74
  v_exp_f32 v75, v75
  v_cvt_pk_bf16_f32 v82, v72, v73
  v_cvt_pk_bf16_f32 v83, v74, v75
  s_setprio 3
  s_waitcnt lgkmcnt(4)
  v_mfma_f32_32x32x16_bf16 v[60:75], v[24:27], v[16:19], 0
  s_add_u32 m0, s50, 49152
  v_exp_f32 v44, v44
  v_exp_f32 v45, v45
  v_exp_f32 v46, v46
  v_exp_f32 v47, v47
  v_mfma_f32_32x32x16_bf16 v[60:75], v[28:31], v[20:23], v[60:75]
  s_waitcnt vmcnt(8)
  s_barrier
  ds_read_b128 v[24:27], v2 offset:16384
  ds_read_b128 v[28:31], v2 offset:17408
  v_exp_f32 v48, v48
  v_cvt_pk_bf16_f32 v76, v44, v45
  v_exp_f32 v49, v49
  v_cvt_pk_bf16_f32 v77, v46, v47
  v_exp_f32 v50, v50
  v_exp_f32 v51, v51
  s_setprio 2
  v_mfma_f32_32x32x16_bf16 v[84:99], v[40:43], v[80:83], v[84:99]
  buffer_load_dwordx4 v4, s[16:19], s49 offen sc1 lds
  s_add_u32 m0, s50, 50176
  ds_read_b64_tr_b16 v[40:41], v3 offset:4352
  ds_read_b64_tr_b16 v[42:43], v10 offset:4352
  v_exp_f32 v52, v52
  v_cvt_pk_bf16_f32 v78, v48, v49
  v_exp_f32 v53, v53
  v_cvt_pk_bf16_f32 v79, v50, v51
  v_exp_f32 v54, v54
  v_exp_f32 v55, v55
  s_waitcnt lgkmcnt(4)
  v_mfma_f32_32x32x16_bf16 v[84:99], v[32:35], v[76:79], v[84:99]
  buffer_load_dwordx4 v5, s[16:19], s49 offen sc1 lds
  s_add_u32 s49, s49, 8192
  ds_read_b64_tr_b16 v[32:33], v3 offset:4096
  ds_read_b64_tr_b16 v[34:35], v10 offset:4096
  v_exp_f32 v56, v56
  v_cvt_pk_bf16_f32 v80, v52, v53
  v_exp_f32 v57, v57
  v_cvt_pk_bf16_f32 v81, v54, v55
  v_exp_f32 v58, v58
  v_exp_f32 v59, v59
  v_cvt_pk_bf16_f32 v82, v56, v57
  v_cvt_pk_bf16_f32 v83, v58, v59
  s_setprio 1
  s_waitcnt lgkmcnt(4)
  v_mfma_f32_32x32x16_bf16 v[44:59], v[24:27], v[16:19], 0
  buffer_load_dwordx4 v[180:183], v4, s[16:19], s55 offen offset:1024 sc1
  v_exp_f32 v60, v60
  v_exp_f32 v61, v61
  v_exp_f32 v62, v62
  v_exp_f32 v63, v63
  v_mfma_f32_32x32x16_bf16 v[44:59], v[28:31], v[20:23], v[44:59]
  buffer_load_dwordx4 v[184:187], v4, s[16:19], s55 offen offset:2048 sc1
  ds_read_b128 v[24:27], v2 offset:20480
  ds_read_b128 v[28:31], v2 offset:21504
  v_exp_f32 v64, v64
  v_cvt_pk_bf16_f32 v76, v60, v61
  v_exp_f32 v65, v65
  v_cvt_pk_bf16_f32 v77, v62, v63
  v_exp_f32 v66, v66
  v_exp_f32 v67, v67
  s_setprio 0
  v_mfma_f32_32x32x16_bf16 v[84:99], v[36:39], v[80:83], v[84:99]
  buffer_load_dwordx4 v[188:191], v4, s[16:19], s55 offen offset:3072 sc1
  ds_read_b64_tr_b16 v[36:37], v3 offset:16640
  ds_read_b64_tr_b16 v[38:39], v10 offset:16640
  v_exp_f32 v68, v68
  v_cvt_pk_bf16_f32 v78, v64, v65
  v_exp_f32 v69, v69
  v_cvt_pk_bf16_f32 v79, v66, v67
  v_exp_f32 v70, v70
  v_exp_f32 v71, v71
  s_waitcnt lgkmcnt(4)
  v_mfma_f32_32x32x16_bf16 v[84:99], v[32:35], v[76:79], v[84:99]
  ds_read_b64_tr_b16 v[32:33], v3 offset:16384
  ds_read_b64_tr_b16 v[34:35], v10 offset:16384
  v_exp_f32 v72, v72
  v_cvt_pk_bf16_f32 v80, v68, v69
  v_exp_f32 v73, v73
  v_cvt_pk_bf16_f32 v81, v70, v71
  v_exp_f32 v74, v74
  v_exp_f32 v75, v75
  v_cvt_pk_bf16_f32 v82, v72, v73
  v_cvt_pk_bf16_f32 v83, v74, v75
  s_setprio 3
  s_waitcnt lgkmcnt(4)
  v_mfma_f32_32x32x16_bf16 v[60:75], v[24:27], v[16:19], 0
  s_add_u32 m0, s50, 0
  v_exp_f32 v44, v44
  v_exp_f32 v45, v45
  v_exp_f32 v46, v46
  v_exp_f32 v47, v47
  v_mfma_f32_32x32x16_bf16 v[60:75], v[28:31], v[20:23], v[60:75]
  s_waitcnt vmcnt(8)
  s_barrier
  ds_read_b128 v[24:27], v2 offset:32768
  ds_read_b128 v[28:31], v2 offset:33792
  v_exp_f32 v48, v48
  v_cvt_pk_bf16_f32 v76, v44, v45
  v_exp_f32 v49, v49
  v_cvt_pk_bf16_f32 v77, v46, v47
  v_exp_f32 v50, v50
  v_exp_f32 v51, v51
  s_setprio 2
  v_mfma_f32_32x32x16_bf16 v[84:99], v[40:43], v[80:83], v[84:99]
  buffer_load_dwordx4 v4, s[16:19], s49 offen sc1 lds
  s_add_u32 m0, s50, 1024
  ds_read_b64_tr_b16 v[40:41], v3 offset:20736
  ds_read_b64_tr_b16 v[42:43], v10 offset:20736
  v_exp_f32 v52, v52
  v_cvt_pk_bf16_f32 v78, v48, v49
  v_exp_f32 v53, v53
  v_cvt_pk_bf16_f32 v79, v50, v51
  v_exp_f32 v54, v54
  v_exp_f32 v55, v55
  s_waitcnt lgkmcnt(4)
  v_mfma_f32_32x32x16_bf16 v[84:99], v[32:35], v[76:79], v[84:99]
  buffer_load_dwordx4 v5, s[16:19], s49 offen sc1 lds
  s_add_u32 s49, s49, 8192
  ds_read_b64_tr_b16 v[32:33], v3 offset:20480
  ds_read_b64_tr_b16 v[34:35], v10 offset:20480
  v_exp_f32 v56, v56
  v_cvt_pk_bf16_f32 v80, v52, v53
  v_exp_f32 v57, v57
  v_cvt_pk_bf16_f32 v81, v54, v55
  v_exp_f32 v58, v58
  v_exp_f32 v59, v59
  v_cvt_pk_bf16_f32 v82, v56, v57
  v_cvt_pk_bf16_f32 v83, v58, v59
  s_setprio 1
  s_waitcnt lgkmcnt(4)
  v_mfma_f32_32x32x16_bf16 v[44:59], v[24:27], v[16:19], 0
  s_add_u32 s55, s55, 4096
  buffer_load_dwordx4 v[192:195], v4, s[16:19], s55 offen offset:0 sc1
  v_exp_f32 v60, v60
  v_exp_f32 v61, v61
  v_exp_f32 v62, v62
  v_exp_f32 v63, v63
  v_mfma_f32_32x32x16_bf16 v[44:59], v[28:31], v[20:23], v[44:59]
  buffer_load_dwordx4 v[196:199], v4, s[16:19], s55 offen offset:1024 sc1
  ds_read_b128 v[24:27], v2 offset:36864
  ds_read_b128 v[28:31], v2 offset:37888
  v_exp_f32 v64, v64
  v_cvt_pk_bf16_f32 v76, v60, v61
  v_exp_f32 v65, v65
  v_cvt_pk_bf16_f32 v77, v62, v63
  v_exp_f32 v66, v66
  v_exp_f32 v67, v67
  s_setprio 0
  v_mfma_f32_32x32x16_bf16 v[84:99], v[36:39], v[80:83], v[84:99]
  buffer_load_dwordx4 v[200:203], v4, s[16:19], s55 offen offset:2048 sc1
  ds_read_b64_tr_b16 v[36:37], v3 offset:33024
  ds_read_b64_tr_b16 v[38:39], v10 offset:33024
  v_exp_f32 v68, v68
  v_cvt_pk_bf16_f32 v78, v64, v65
  v_exp_f32 v69, v69
  v_cvt_pk_bf16_f32 v79, v66, v67
  v_exp_f32 v70, v70
  v_exp_f32 v71, v71
  s_waitcnt lgkmcnt(4)
  v_mfma_f32_32x32x16_bf16 v[84:99], v[32:35], v[76:79], v[84:99]
  ds_read_b64_tr_b16 v[32:33], v3 offset:32768
  ds_read_b64_tr_b16 v[34:35], v10 offset:32768
  v_exp_f32 v72, v72
  v_cvt_pk_bf16_f32 v80, v68, v69
  v_exp_f32 v73, v73
  v_cvt_pk_bf16_f32 v81, v70, v71
  v_exp_f32 v74, v74
  v_exp_f32 v75, v75
  v_cvt_pk_bf16_f32 v82, v72, v73
  v_cvt_pk_bf16_f32 v83, v74, v75
  s_setprio 3
  s_waitcnt lgkmcnt(4)
  v_mfma_f32_32x32x16_bf16 v[60:75], v[24:27], v[16:19], 0
  s_add_u32 m0, s50, 16384
  v_exp_f32 v44, v44
  v_exp_f32 v45, v45
  v_exp_f32 v46, v46
  v_exp_f32 v47, v47
  v_mfma_f32_32x32x16_bf16 v[60:75], v[28:31], v[20:23], v[60:75]
  s_waitcnt vmcnt(8)
  s_barrier
  ds_read_b128 v[24:27], v2 offset:49152
  ds_read_b128 v[28:31], v2 offset:50176
  v_exp_f32 v48, v48
  v_cvt_pk_bf16_f32 v76, v44, v45
  v_exp_f32 v49, v49
  v_cvt_pk_bf16_f32 v77, v46, v47
  v_exp_f32 v50, v50
  v_exp_f32 v51, v51
  s_setprio 2
  v_mfma_f32_32x32x16_bf16 v[84:99], v[40:43], v[80:83], v[84:99]
  buffer_load_dwordx4 v4, s[16:19], s49 offen sc1 lds
  s_add_u32 m0, s50, 17408
  ds_read_b64_tr_b16 v[40:41], v3 offset:37120
  ds_read_b64_tr_b16 v[42:43], v10 offset:37120
  v_exp_f32 v52, v52
  v_cvt_pk_bf16_f32 v78, v48, v49
  v_exp_f32 v53, v53
  v_cvt_pk_bf16_f32 v79, v50, v51
  v_exp_f32 v54, v54
  v_exp_f32 v55, v55
  s_waitcnt lgkmcnt(4)
  v_mfma_f32_32x32x16_bf16 v[84:99], v[32:35], v[76:79], v[84:99]
  buffer_load_dwordx4 v5, s[16:19], s49 offen sc1 lds
  s_add_u32 s49, s49, 8192
  ds_read_b64_tr_b16 v[32:33], v3 offset:36864
  ds_read_b64_tr_b16 v[34:35], v10 offset:36864
  v_exp_f32 v56, v56
  v_cvt_pk_bf16_f32 v80, v52, v53
  v_exp_f32 v57, v57
  v_cvt_pk_bf16_f32 v81, v54, v55
  v_exp_f32 v58, v58
  v_exp_f32 v59, v59
  v_cvt_pk_bf16_f32 v82, v56, v57
  v_cvt_pk_bf16_f32 v83, v58, v59
  s_setprio 1
  s_waitcnt lgkmcnt(4)
  v_mfma_f32_32x32x16_bf16 v[44:59], v[24:27], v[16:19], 0
  buffer_load_dwordx4 v[204:207], v4, s[16:19], s55 offen offset:3072 sc1
  v_exp_f32 v60, v60
  v_exp_f32 v61, v61
  v_exp_f32 v62, v62
  v_exp_f32 v63, v63
  v_mfma_f32_32x32x16_bf16 v[44:59], v[28:31], v[20:23], v[44:59]
  s_add_u32 s55, s55, 4096
  buffer_load_dwordx4 v[208:211], v4, s[16:19], s55 offen offset:0 sc1
  ds_read_b128 v[24:27], v2 offset:53248
  ds_read_b128 v[28:31], v2 offset:54272
  v_exp_f32 v64, v64
  v_cvt_pk_bf16_f32 v76, v60, v61
  v_exp_f32 v65, v65
  v_cvt_pk_bf16_f32 v77, v62, v63
  v_exp_f32 v66, v66
  v_exp_f32 v67, v67
  s_setprio 0
  v_mfma_f32_32x32x16_bf16 v[84:99], v[36:39], v[80:83], v[84:99]
  buffer_load_dwordx4 v[212:215], v4, s[16:19], s55 offen offset:1024 sc1
  ds_read_b64_tr_b16 v[36:37], v3 offset:49408
  ds_read_b64_tr_b16 v[38:39], v10 offset:49408
  v_exp_f32 v68, v68
  v_cvt_pk_bf16_f32 v78, v64, v65
  v_exp_f32 v69, v69
  v_cvt_pk_bf16_f32 v79, v66, v67
  v_exp_f32 v70, v70
  v_exp_f32 v71, v71
  s_waitcnt lgkmcnt(4)
  v_mfma_f32_32x32x16_bf16 v[84:99], v[32:35], v[76:79], v[84:99]
  ds_read_b64_tr_b16 v[32:33], v3 offset:49152
  ds_read_b64_tr_b16 v[34:35], v10 offset:49152
  v_exp_f32 v72, v72
  v_cvt_pk_bf16_f32 v80, v68, v69
  v_exp_f32 v73, v73
  v_cvt_pk_bf16_f32 v81, v70, v71
  v_exp_f32 v74, v74
  v_exp_f32 v75, v75
  v_cvt_pk_bf16_f32 v82, v72, v73
  v_cvt_pk_bf16_f32 v83, v74, v75
  s_setprio 3
  s_waitcnt lgkmcnt(4)
  v_mfma_f32_32x32x16_bf16 v[60:75], v[24:27], v[16:19], 0
  s_add_u32 m0, s50, 32768
  v_exp_f32 v44, v44
  v_exp_f32 v45, v45
  v_exp_f32 v46, v46
  v_exp_f32 v47, v47
  v_mfma_f32_32x32x16_bf16 v[60:75], v[28:31], v[20:23], v[60:75]
  s_waitcnt vmcnt(8)
  s_barrier
  ds_read_b128 v[24:27], v2 offset:0
  ds_read_b128 v[28:31], v2 offset:1024
  v_exp_f32 v48, v48
  v_cvt_pk_bf16_f32 v76, v44, v45
  v_exp_f32 v49, v49
  v_cvt_pk_bf16_f32 v77, v46, v47
  v_exp_f32 v50, v50
  v_exp_f32 v51, v51
  s_setprio 2
  v_mfma_f32_32x32x16_bf16 v[84:99], v[40:43], v[80:83], v[84:99]
  buffer_load_dwordx4 v4, s[16:19], s49 offen sc1 lds
  s_add_u32 m0, s50, 33792
  ds_read_b64_tr_b16 v[40:41], v3 offset:53504
  ds_read_b64_tr_b16 v[42:43], v10 offset:53504
  v_exp_f32 v52, v52
  v_cvt_pk_bf16_f32 v78, v48, v49
  v_exp_f32 v53, v53
  v_cvt_pk_bf16_f32 v79, v50, v51
  v_exp_f32 v54, v54
  v_exp_f32 v55, v55
  s_waitcnt lgkmcnt(4)
  v_mfma_f32_32x32x16_bf16 v[84:99], v[32:35], v[76:79], v[84:99]
  buffer_load_dwordx4 v5, s[16:19], s49 offen sc1 lds
  s_add_u32 s49, s49, 8192
  ds_read_b64_tr_b16 v[32:33], v3 offset:53248
  ds_read_b64_tr_b16 v[34:35], v10 offset:53248
  v_exp_f32 v56, v56
  v_cvt_pk_bf16_f32 v80, v52, v53
  v_exp_f32 v57, v57
  v_cvt_pk_bf16_f32 v81, v54, v55
  v_exp_f32 v58, v58
  v_exp_f32 v59, v59
  v_cvt_pk_bf16_f32 v82, v56, v57
  v_cvt_pk_bf16_f32 v83, v58, v59
  s_setprio 1
  s_waitcnt lgkmcnt(4)
  v_mfma_f32_32x32x16_bf16 v[44:59], v[24:27], v[16:19], 0
  buffer_load_dwordx4 v[216:219], v4, s[16:19], s55 offen offset:2048 sc1
  v_exp_f32 v60, v60
  v_exp_f32 v61, v61
  v_exp_f32 v62, v62
  v_exp_f32 v63, v63
  v_mfma_f32_32x32x16_bf16 v[44:59], v[28:31], v[20:23], v[44:59]
  buffer_load_dwordx4 v[220:223], v4, s[16:19], s55 offen offset:3072 sc1
  ds_read_b128 v[24:27], v2 offset:4096
  ds_read_b128 v[28:31], v2 offset:5120
  v_exp_f32 v64, v64
  v_cvt_pk_bf16_f32 v76, v60, v61
  v_exp_f32 v65, v65
  v_cvt_pk_bf16_f32 v77, v62, v63
  v_exp_f32 v66, v66
  v_exp_f32 v67, v67
  s_setprio 0
  v_mfma_f32_32x32x16_bf16 v[84:99], v[36:39], v[80:83], v[84:99]
  s_add_u32 s55, s55, 4096
  buffer_load_dwordx4 v[224:227], v4, s[16:19], s55 offen offset:0 sc1
  ds_read_b64_tr_b16 v[36:37], v3 offset:256
  ds_read_b64_tr_b16 v[38:39], v10 offset:256
  v_exp_f32 v68, v68
  v_cvt_pk_bf16_f32 v78, v64, v65
  v_exp_f32 v69, v69
  v_cvt_pk_bf16_f32 v79, v66, v67
  v_exp_f32 v70, v70
  v_exp_f32 v71, v71
  s_waitcnt lgkmcnt(4)
  v_mfma_f32_32x32x16_bf16 v[84:99], v[32:35], v[76:79], v[84:99]
  ds_read_b64_tr_b16 v[32:33], v3 offset:0
  ds_read_b64_tr_b16 v[34:35], v10 offset:0
  v_exp_f32 v72, v72
  v_cvt_pk_bf16_f32 v80, v68, v69
  v_exp_f32 v73, v73
  v_cvt_pk_bf16_f32 v81, v70, v71
  v_exp_f32 v74, v74
  v_exp_f32 v75, v75
  v_cvt_pk_bf16_f32 v82, v72, v73
  v_cvt_pk_bf16_f32 v83, v74, v75
  s_setprio 3
  s_waitcnt lgkmcnt(4)
  v_mfma_f32_32x32x16_bf16 v[60:75], v[24:27], v[16:19], 0
  s_add_u32 m0, s50, 49152
  v_exp_f32 v44, v44
  v_exp_f32 v45, v45
  v_exp_f32 v46, v46
  v_exp_f32 v47, v47
  v_mfma_f32_32x32x16_bf16 v[60:75], v[28:31], v[20:23], v[60:75]
  s_waitcnt vmcnt(8)
  s_barrier
  ds_read_b128 v[24:27], v2 offset:16384
  ds_read_b128 v[28:31], v2 offset:17408
  v_exp_f32 v48, v48
  v_cvt_pk_bf16_f32 v76, v44, v45
  v_exp_f32 v49, v49
  v_cvt_pk_bf16_f32 v77, v46, v47
  v_exp_f32 v50, v50
  v_exp_f32 v51, v51
  s_setprio 2
  v_mfma_f32_32x32x16_bf16 v[84:99], v[40:43], v[80:83], v[84:99]
  buffer_load_dwordx4 v4, s[16:19], s49 offen sc1 lds
  s_add_u32 m0, s50, 50176
  ds_read_b64_tr_b16 v[40:41], v3 offset:4352
  ds_read_b64_tr_b16 v[42:43], v10 offset:4352
  v_exp_f32 v52, v52
  v_cvt_pk_bf16_f32 v78, v48, v49
  v_exp_f32 v53, v53
  v_cvt_pk_bf16_f32 v79, v50, v51
  v_exp_f32 v54, v54
  v_exp_f32 v55, v55
  s_waitcnt lgkmcnt(4)
  v_mfma_f32_32x32x16_bf16 v[84:99], v[32:35], v[76:79], v[84:99]
  buffer_load_dwordx4 v5, s[16:19], s49 offen sc1 lds
  s_add_u32 s49, s49, 8192
  ds_read_b64_tr_b16 v[32:33], v3 offset:4096
  ds_read_b64_tr_b16 v[34:35], v10 offset:4096
  v_exp_f32 v56, v56
  v_cvt_pk_bf16_f32 v80, v52, v53
  v_exp_f32 v57, v57
  v_cvt_pk_bf16_f32 v81, v54, v55
  v_exp_f32 v58, v58
  v_exp_f32 v59, v59
  v_cvt_pk_bf16_f32 v82, v56, v57
  v_cvt_pk_bf16_f32 v83, v58, v59
  s_setprio 1
  s_waitcnt lgkmcnt(4)
  v_mfma_f32_32x32x16_bf16 v[44:59], v[24:27], v[16:19], 0
  buffer_load_dwordx4 v[228:231], v4, s[16:19], s55 offen offset:1024 sc1
  v_exp_f32 v60, v60
  v_exp_f32 v61, v61
  v_exp_f32 v62, v62
  v_exp_f32 v63, v63
  v_mfma_f32_32x32x16_bf16 v[44:59], v[28:31], v[20:23], v[44:59]
  buffer_load_dwordx4 v[232:235], v4, s[16:19], s55 offen offset:2048 sc1
  ds_read_b128 v[24:27], v2 offset:20480
  ds_read_b128 v[28:31], v2 offset:21504
  v_exp_f32 v64, v64
  v_cvt_pk_bf16_f32 v76, v60, v61
  v_exp_f32 v65, v65
  v_cvt_pk_bf16_f32 v77, v62, v63
  v_exp_f32 v66, v66
  v_exp_f32 v67, v67
  s_setprio 0
  v_mfma_f32_32x32x16_bf16 v[84:99], v[36:39], v[80:83], v[84:99]
  buffer_load_dwordx4 v[236:239], v4, s[16:19], s55 offen offset:3072 sc1
  ds_read_b64_tr_b16 v[36:37], v3 offset:16640
  ds_read_b64_tr_b16 v[38:39], v10 offset:16640
  v_exp_f32 v68, v68
  v_cvt_pk_bf16_f32 v78, v64, v65
  v_exp_f32 v69, v69
  v_cvt_pk_bf16_f32 v79, v66, v67
  v_exp_f32 v70, v70
  v_exp_f32 v71, v71
  s_waitcnt lgkmcnt(4)
  v_mfma_f32_32x32x16_bf16 v[84:99], v[32:35], v[76:79], v[84:99]
  ds_read_b64_tr_b16 v[32:33], v3 offset:16384
  ds_read_b64_tr_b16 v[34:35], v10 offset:16384
  v_exp_f32 v72, v72
  v_cvt_pk_bf16_f32 v80, v68, v69
  v_exp_f32 v73, v73
  v_cvt_pk_bf16_f32 v81, v70, v71
  v_exp_f32 v74, v74
  v_exp_f32 v75, v75
  v_cvt_pk_bf16_f32 v82, v72, v73
  v_cvt_pk_bf16_f32 v83, v74, v75
  s_setprio 3
  s_waitcnt lgkmcnt(4)
  v_mfma_f32_32x32x16_bf16 v[60:75], v[24:27], v[16:19], 0
  v_exp_f32 v44, v44
  v_exp_f32 v45, v45
  v_exp_f32 v46, v46
  v_exp_f32 v47, v47
  v_mfma_f32_32x32x16_bf16 v[60:75], v[28:31], v[20:23], v[60:75]
  s_waitcnt vmcnt(8)
  s_barrier
  ds_read_b128 v[24:27], v2 offset:32768
  ds_read_b128 v[28:31], v2 offset:33792
  v_exp_f32 v48, v48
  v_cvt_pk_bf16_f32 v76, v44, v45
  v_exp_f32 v49, v49
  v_cvt_pk_bf16_f32 v77, v46, v47
  v_exp_f32 v50, v50
  v_exp_f32 v51, v51
  s_setprio 2
  v_mfma_f32_32x32x16_bf16 v[84:99], v[40:43], v[80:83], v[84:99]
  ds_read_b64_tr_b16 v[40:41], v3 offset:20736
  ds_read_b64_tr_b16 v[42:43], v10 offset:20736
  v_exp_f32 v52, v52
  v_cvt_pk_bf16_f32 v78, v48, v49
  v_exp_f32 v53, v53
  v_cvt_pk_bf16_f32 v79, v50, v51
  v_exp_f32 v54, v54
  v_exp_f32 v55, v55
  s_waitcnt lgkmcnt(4)
  v_mfma_f32_32x32x16_bf16 v[84:99], v[32:35], v[76:79], v[84:99]
  ds_read_b64_tr_b16 v[32:33], v3 offset:20480
  ds_read_b64_tr_b16 v[34:35], v10 offset:20480
  v_exp_f32 v56, v56
  v_cvt_pk_bf16_f32 v80, v52, v53
  v_exp_f32 v57, v57
  v_cvt_pk_bf16_f32 v81, v54, v55
  v_exp_f32 v58, v58
  v_exp_f32 v59, v59
  v_cvt_pk_bf16_f32 v82, v56, v57
  v_cvt_pk_bf16_f32 v83, v58, v59
  s_setprio 1
  s_waitcnt lgkmcnt(4)
  v_mfma_f32_32x32x16_bf16 v[44:59], v[24:27], v[16:19], 0
  s_add_u32 s55, s55, 4096
  buffer_load_dwordx4 v[240:243], v4, s[16:19], s55 offen offset:0 sc1
  v_exp_f32 v60, v60
  v_exp_f32 v61, v61
  v_exp_f32 v62, v62
  v_exp_f32 v63, v63
  v_mfma_f32_32x32x16_bf16 v[44:59], v[28:31], v[20:23], v[44:59]
  buffer_load_dwordx4 v[244:247], v4, s[16:19], s55 offen offset:1024 sc1
  ds_read_b128 v[24:27], v2 offset:36864
  ds_read_b128 v[28:31], v2 offset:37888
  v_exp_f32 v64, v64
  v_cvt_pk_bf16_f32 v76, v60, v61
  v_exp_f32 v65, v65
  v_cvt_pk_bf16_f32 v77, v62, v63
  v_exp_f32 v66, v66
  v_exp_f32 v67, v67
  s_setprio 0
  v_mfma_f32_32x32x16_bf16 v[84:99], v[36:39], v[80:83], v[84:99]
  buffer_load_dwordx4 v[248:251], v4, s[16:19], s55 offen offset:2048 sc1
  ds_read_b64_tr_b16 v[36:37], v3 offset:33024
  ds_read_b64_tr_b16 v[38:39], v10 offset:33024
  v_exp_f32 v68, v68
  v_cvt_pk_bf16_f32 v78, v64, v65
  v_exp_f32 v69, v69
  v_cvt_pk_bf16_f32 v79, v66, v67
  v_exp_f32 v70, v70
  v_exp_f32 v71, v71
  s_waitcnt lgkmcnt(4)
  v_mfma_f32_32x32x16_bf16 v[84:99], v[32:35], v[76:79], v[84:99]
  ds_read_b64_tr_b16 v[32:33], v3 offset:32768
  ds_read_b64_tr_b16 v[34:35], v10 offset:32768
  v_exp_f32 v72, v72
  v_cvt_pk_bf16_f32 v80, v68, v69
  v_exp_f32 v73, v73
  v_cvt_pk_bf16_f32 v81, v70, v71
  v_exp_f32 v74, v74
  v_exp_f32 v75, v75
  v_cvt_pk_bf16_f32 v82, v72, v73
  v_cvt_pk_bf16_f32 v83, v74, v75
  s_setprio 3
  s_waitcnt lgkmcnt(4)
  v_mfma_f32_32x32x16_bf16 v[60:75], v[24:27], v[16:19], 0
  v_exp_f32 v44, v44
  v_exp_f32 v45, v45
  v_exp_f32 v46, v46
  v_exp_f32 v47, v47
  v_mfma_f32_32x32x16_bf16 v[60:75], v[28:31], v[20:23], v[60:75]
  s_waitcnt vmcnt(6)
  s_barrier
  ds_read_b128 v[24:27], v2 offset:49152
  ds_read_b128 v[28:31], v2 offset:50176
  v_exp_f32 v48, v48
  v_cvt_pk_bf16_f32 v76, v44, v45
  v_exp_f32 v49, v49
  v_cvt_pk_bf16_f32 v77, v46, v47
  v_exp_f32 v50, v50
  v_exp_f32 v51, v51
  s_setprio 2
  v_mfma_f32_32x32x16_bf16 v[84:99], v[40:43], v[80:83], v[84:99]
  ds_read_b64_tr_b16 v[40:41], v3 offset:37120
  ds_read_b64_tr_b16 v[42:43], v10 offset:37120
  v_exp_f32 v52, v52
  v_cvt_pk_bf16_f32 v78, v48, v49
  v_exp_f32 v53, v53
  v_cvt_pk_bf16_f32 v79, v50, v51
  v_exp_f32 v54, v54
  v_exp_f32 v55, v55
  s_waitcnt lgkmcnt(4)
  v_mfma_f32_32x32x16_bf16 v[84:99], v[32:35], v[76:79], v[84:99]
  ds_read_b64_tr_b16 v[32:33], v3 offset:36864
  ds_read_b64_tr_b16 v[34:35], v10 offset:36864
  v_exp_f32 v56, v56
  v_cvt_pk_bf16_f32 v80, v52, v53
  v_exp_f32 v57, v57
  v_cvt_pk_bf16_f32 v81, v54, v55
  v_exp_f32 v58, v58
  v_exp_f32 v59, v59
  v_cvt_pk_bf16_f32 v82, v56, v57
  v_cvt_pk_bf16_f32 v83, v58, v59
  s_setprio 1
  s_waitcnt lgkmcnt(4)
  v_mfma_f32_32x32x16_bf16 v[44:59], v[24:27], v[16:19], 0
  buffer_load_dwordx4 v[252:255], v4, s[16:19], s55 offen offset:3072 sc1
  v_exp_f32 v60, v60
  v_exp_f32 v61, v61
  v_exp_f32 v62, v62
  v_exp_f32 v63, v63
  v_mfma_f32_32x32x16_bf16 v[44:59], v[28:31], v[20:23], v[44:59]
  ds_read_b128 v[24:27], v2 offset:53248
  ds_read_b128 v[28:31], v2 offset:54272
  v_exp_f32 v64, v64
  v_cvt_pk_bf16_f32 v76, v60, v61
  v_exp_f32 v65, v65
  v_cvt_pk_bf16_f32 v77, v62, v63
  v_exp_f32 v66, v66
  v_exp_f32 v67, v67
  s_setprio 0
  v_mfma_f32_32x32x16_bf16 v[84:99], v[36:39], v[80:83], v[84:99]
  ds_read_b64_tr_b16 v[36:37], v3 offset:49408
  ds_read_b64_tr_b16 v[38:39], v10 offset:49408
  v_exp_f32 v68, v68
  v_cvt_pk_bf16_f32 v78, v64, v65
  v_exp_f32 v69, v69
  v_cvt_pk_bf16_f32 v79, v66, v67
  v_exp_f32 v70, v70
  v_exp_f32 v71, v71
  s_waitcnt lgkmcnt(4)
  v_mfma_f32_32x32x16_bf16 v[84:99], v[32:35], v[76:79], v[84:99]
  ds_read_b64_tr_b16 v[32:33], v3 offset:49152
  ds_read_b64_tr_b16 v[34:35], v10 offset:49152
  v_exp_f32 v72, v72
  v_cvt_pk_bf16_f32 v80, v68, v69
  v_exp_f32 v73, v73
  v_cvt_pk_bf16_f32 v81, v70, v71
  v_exp_f32 v74, v74
  v_exp_f32 v75, v75
  v_cvt_pk_bf16_f32 v82, v72, v73
  v_cvt_pk_bf16_f32 v83, v74, v75
  s_setprio 3
  s_waitcnt lgkmcnt(4)
  v_mfma_f32_32x32x16_bf16 v[60:75], v[24:27], v[16:19], 0
  v_exp_f32 v44, v44
  v_exp_f32 v45, v45
  v_exp_f32 v46, v46
  v_exp_f32 v47, v47
  v_mfma_f32_32x32x16_bf16 v[60:75], v[28:31], v[20:23], v[60:75]
  v_exp_f32 v48, v48
  v_cvt_pk_bf16_f32 v76, v44, v45
  v_exp_f32 v49, v49
  v_cvt_pk_bf16_f32 v77, v46, v47
  v_exp_f32 v50, v50
  v_exp_f32 v51, v51
  s_setprio 2
  v_mfma_f32_32x32x16_bf16 v[84:99], v[40:43], v[80:83], v[84:99]
  ds_read_b64_tr_b16 v[40:41], v3 offset:53504
  ds_read_b64_tr_b16 v[42:43], v10 offset:53504
  v_exp_f32 v52, v52
  v_cvt_pk_bf16_f32 v78, v48, v49
  v_exp_f32 v53, v53
  v_cvt_pk_bf16_f32 v79, v50, v51
  v_exp_f32 v54, v54
  v_exp_f32 v55, v55
  s_waitcnt lgkmcnt(2)
  v_mfma_f32_32x32x16_bf16 v[84:99], v[32:35], v[76:79], v[84:99]
  ds_read_b64_tr_b16 v[32:33], v3 offset:53248
  ds_read_b64_tr_b16 v[34:35], v10 offset:53248
  v_exp_f32 v56, v56
  v_cvt_pk_bf16_f32 v80, v52, v53
  v_exp_f32 v57, v57
  v_cvt_pk_bf16_f32 v81, v54, v55
  v_exp_f32 v58, v58
  v_exp_f32 v59, v59
  v_cvt_pk_bf16_f32 v82, v56, v57
  v_cvt_pk_bf16_f32 v83, v58, v59
  s_setprio 1
  v_exp_f32 v60, v60
  v_exp_f32 v61, v61
  v_exp_f32 v62, v62
  v_exp_f32 v63, v63
  v_exp_f32 v64, v64
  v_cvt_pk_bf16_f32 v76, v60, v61
  v_exp_f32 v65, v65
  v_cvt_pk_bf16_f32 v77, v62, v63
  v_exp_f32 v66, v66
  v_exp_f32 v67, v67
  s_setprio 0
  v_mfma_f32_32x32x16_bf16 v[84:99], v[36:39], v[80:83], v[84:99]
  v_exp_f32 v68, v68
  v_cvt_pk_bf16_f32 v78, v64, v65
  v_exp_f32 v69, v69
  v_cvt_pk_bf16_f32 v79, v66, v67
  v_exp_f32 v70, v70
  v_exp_f32 v71, v71
  s_waitcnt lgkmcnt(0)
  v_mfma_f32_32x32x16_bf16 v[84:99], v[32:35], v[76:79], v[84:99]
  v_exp_f32 v72, v72
  v_cvt_pk_bf16_f32 v80, v68, v69
  v_exp_f32 v73, v73
  v_cvt_pk_bf16_f32 v81, v70, v71
  v_exp_f32 v74, v74
  v_exp_f32 v75, v75
  v_cvt_pk_bf16_f32 v82, v72, v73
  v_cvt_pk_bf16_f32 v83, v74, v75
  s_setprio 0
  s_waitcnt lgkmcnt(0)
  v_mfma_f32_32x32x16_bf16 v[84:99], v[40:43], v[80:83], v[84:99]
  s_cmp_eq_u32 s34, 0
  s_cselect_b64 s[46:47], -1, 0
  v_mov_b32 v105, 0
  v_mov_b32 v103, s54
  s_nop 7
  v_cndmask_b32 v104, v88, v96, s[46:47]
  ds_write_b128 v11, v[92:95]
  ds_write_b128 v11, v[96:99] offset:1024
  ds_write_b32 v13, v104 offset:16384
  v_fma_f32 v105, v84, 0, v105
  v_fma_f32 v105, v85, 0, v105
  v_fma_f32 v105, v86, 0, v105
  v_fma_f32 v105, v87, 0, v105
  v_fma_f32 v105, v88, 0, v105
  v_fma_f32 v105, v89, 0, v105
  v_fma_f32 v105, v90, 0, v105
  v_fma_f32 v105, v91, 0, v105
  v_fma_f32 v105, v92, 0, v105
  v_fma_f32 v105, v93, 0, v105
  v_fma_f32 v105, v94, 0, v105
  v_fma_f32 v105, v95, 0, v105
  v_fma_f32 v105, v96, 0, v105
  v_fma_f32 v105, v97, 0, v105
  v_fma_f32 v105, v98, 0, v105
  v_fma_f32 v105, v99, 0, v105
  v_cmp_u_f32 vcc, v105, v105
  v_mov_b32 v105, 0x76800000
  v_cmp_nlt_f32 s[44:45], v104, v105
  s_nop 0
  s_and_b64 s[44:45], s[44:45], s[42:43]
  s_or_b64 vcc, vcc, s[44:45]
  s_cmp_lg_u64 vcc, 0
  s_cselect_b32 s44, 1, 0
  v_mov_b32 v106, s44
  ds_write_b32 v103, v106
  s_waitcnt lgkmcnt(0)
  s_barrier
  ds_read_b32 v105, v15 offset:20480
  ds_read_b128 v[44:47], v12
  ds_read_b128 v[48:51], v12 offset:1024
  ds_read_b32 v106, v14 offset:16384
  v_lshrrev_b32 v72, 5, v1
  v_mul_u32_u24 v72, 4, v72
  v_bfe_u32 v73, v1, 2, 2
  v_add_u32 v72, v72, v73
  v_lshlrev_b32 v2, 7, v72
  v_bfe_u32 v72, v1, 4, 1
  v_lshlrev_b32 v72, 5, v72
  v_and_b32 v73, 3, v1
  v_lshlrev_b32 v73, 3, v73
  v_add_u32 v72, v72, v73
  v_bfe_u32 v73, v1, 3, 1
  v_lshlrev_b32 v73, 6, v73
  v_xor_b32 v72, v72, v73
  v_add_u32 v2, v2, v72
  s_lshl_b32 s44, s39, 13
  v_add_u32 v2, s44, v2
  v_xor_b32 v3, 64, v2
  v_add_u32 v10, 0x10000, v2
  v_add_u32 v11, 0x10000, v3
  v_add_u32 v12, 0x20000, v2
  v_add_u32 v13, 0x20000, v3
  s_waitcnt lgkmcnt(3)
  s_cmp_lg_u32 s52, 0
  s_cbranch_scc1 L_att_finish
  v_cmp_ne_u32 vcc, 0, v105
  s_nop 0
  s_cbranch_vccnz L_att_fallback
L_att_finish:
  s_waitcnt lgkmcnt(0)
  v_add_f32 v104, v104, v106
  v_add_f32 v84, v84, v44
  v_add_f32 v85, v85, v45
  v_add_f32 v86, v86, v46
  v_add_f32 v87, v87, v47
  v_add_f32 v88, v88, v48
  v_add_f32 v89, v89, v49
  v_add_f32 v90, v90, v50
  v_add_f32 v91, v91, v51
  v_mov_b32 v101, v104
  v_mov_b32 v102, v104
  s_nop 1
  v_permlane32_swap_b32 v101, v102
  v_rcp_f32 v102, v102
  s_nop 0
  v_mul_f32 v84, v102, v84
  v_mul_f32 v85, v102, v85
  v_mul_f32 v86, v102, v86
  v_mul_f32 v87, v102, v87
  v_mul_f32 v88, v102, v88
  v_mul_f32 v89, v102, v89
  v_mul_f32 v90, v102, v90
  v_mul_f32 v91, v102, v91
  v_cvt_pk_bf16_f32 v76, v84, v85
  v_cvt_pk_bf16_f32 v77, v86, v87
  v_cvt_pk_bf16_f32 v78, v88, v89
  v_cvt_pk_bf16_f32 v79, v90, v91
  v_cndmask_b32 v78, v78, 0, s[30:31]
  v_cndmask_b32 v79, v79, 0, s[30:31]
  buffer_store_dwordx4 v[76:79], v4, s[16:19], s63 offen sc1
  s_branch L_att_done
L_att_fallback:
  s_waitcnt vmcnt(0) lgkmcnt(0)
  s_barrier
  v_lshlrev_b32 v4, 4, v1
  v_add_u32 v5, 1024, v4
  s_lshl_b32 s44, s34, 13
  v_add_u32 v2, s44, v4
  v_bfe_u32 v165, v1, 4, 1
  v_xor_b32 v165, s34, v165
  v_and_b32 v166, 1, v1
  v_lshrrev_b32 v167, 5, v1
  v_xor_b32 v167, v167, v166
  v_lshlrev_b32 v167, 2, v167
  v_bfe_u32 v168, v1, 2, 2
  v_add_u32 v167, v167, v168
  v_lshlrev_b32 v167, 4, v167
  v_lshlrev_b32 v168, 10, v165
  v_add_u32 v167, v167, v168
  v_lshlrev_b32 v168, 9, v166
  v_add_u32 v167, v167, v168
  v_bfe_u32 v168, v1, 1, 1
  v_lshlrev_b32 v168, 3, v168
  v_add_u32 v167, v167, v168
  s_add_u32 s44, s44, 2048
  v_add_u32 v167, s44, v167
  v_lshlrev_b32 v168, 7, v165
  v_add_u32 v3, v167, v168
  v_xor_b32 v168, 128, v168
  v_add_u32 v10, v167, v168
  s_lshl_b32 s44, s32, 6
  s_lshl_b32 s45, s34, 5
  s_add_u32 s44, s44, s45
  s_lshl_b32 s44, s44, 12
  s_lshl_b32 s45, s35, 11
  s_add_u32 s44, s44, s45
  s_add_u32 s48, s44, 2097152
  s_lshl_b32 s50, s34, 13
  s_add_u32 s50, s50, s45
  s_mov_b32 s8, s76
  s_and_b32 s9, s77, 0xffff
  s_mov_b32 s10, 0x188000
  s_mov_b32 s11, 0x00020000
  s_mov_b32 s12, s68
  s_and_b32 s13, s69, 0xffff
  s_mov_b32 s14, 0x62000
  s_mov_b32 s15, 0x00020000
  v_lshrrev_b32 v165, 3, v1
  v_mul_u32_u24 v6, 896, v165
  v_bfe_u32 v165, v1, 4, 1
  v_lshlrev_b32 v165, 2, v165
  v_and_b32 v166, 7, v1
  v_xor_b32 v166, v166, v165
  v_lshlrev_b32 v166, 4, v166
  v_add_u32 v6, v6, v166
  v_add_u32 v7, 13312, v6
  v_add_u32 v8, 26624, v6
  v_add_u32 v9, 39936, v6
  s_mul_i32 s56, s39, 448
  s_lshl_b32 s44, s38, 3
  s_add_u32 s56, s56, s44
  s_mul_i32 s56, s56, 896
  s_lshl_b32 s45, s37, 7
  s_add_u32 s56, s56, s45
  s_mul_i32 s57, s39, 112
  s_add_u32 s57, s57, s44
  s_mul_i32 s57, s57, 896
  s_add_u32 s57, s57, s45
  s_lshl_b32 s58, s26, 12
  s_lshl_b32 s44, s26, 11
  v_add_u32 v11, s44, v4
  s_xor_b32 s44, s44, 8192
  v_add_u32 v12, s44, v4
  s_lshl_b32 s44, s26, 8
  v_lshlrev_b32 v165, 2, v1
  v_add_u32 v13, s44, v165
  s_xor_b32 s44, s44, 1024
  v_add_u32 v14, s44, v165
  v_and_b32 v15, 7, v1
  v_lshlrev_b32 v15, 2, v15
  s_lshl_b32 s54, s26, 2
  s_add_u32 s54, s54, 20480
  s_lshl_b32 s44, s33, 2
  s_add_u32 s44, s44, s35
  s_lshl_b32 s44, s44, 4
  s_add_u32 s44, s44, s32
  s_lshl_b32 s44, s44, 11
  s_lshl_b32 s45, s34, 10
  s_add_u32 s44, s44, s45
  s_add_u32 s63, s44, 14680064
  s_mov_b32 s52, 1
  s_mov_b64 exec, s[42:43]
  v_mov_b32 v22, 0
  s_mov_b64 exec, -1
  v_mov_b32 v104, 0xff800000
  s_mov_b32 s49, s48
  s_mov_b32 s51, 0
L_att_fb_loop:
  s_add_u32 m0, s50, 0
  s_nop 0
  buffer_load_dwordx4 v4, s[16:19], s49 offen sc1 lds
  s_add_u32 m0, s50, 1024
  s_nop 0
  buffer_load_dwordx4 v5, s[16:19], s49 offen sc1 lds
  s_add_u32 s49, s49, 8192
  s_waitcnt vmcnt(0)
  s_barrier
  ds_read_b128 v[24:27], v2 offset:0
  ds_read_b128 v[28:31], v2 offset:1024
  s_waitcnt lgkmcnt(0)
  v_mfma_f32_32x32x16_bf16 v[44:59], v[24:27], v[16:19], 0
  v_mfma_f32_32x32x16_bf16 v[44:59], v[28:31], v[20:23], v[44:59]
  s_nop 11
  v_max3_f32 v100, v44, v45, v46
  v_max3_f32 v100, v100, v47, v48
  v_max3_f32 v100, v100, v49, v50
  v_max3_f32 v100, v100, v51, v52
  v_max3_f32 v100, v100, v53, v54
  v_max3_f32 v100, v100, v55, v56
  v_max3_f32 v100, v100, v57, v58
  v_max3_f32 v104, v104, v100, v59
  ds_read_b128 v[24:27], v2 offset:4096
  ds_read_b128 v[28:31], v2 offset:5120
  s_waitcnt lgkmcnt(0)
  v_mfma_f32_32x32x16_bf16 v[44:59], v[24:27], v[16:19], 0
  v_mfma_f32_32x32x16_bf16 v[44:59], v[28:31], v[20:23], v[44:59]
  s_nop 11
  v_max3_f32 v100, v44, v45, v46
  v_max3_f32 v100, v100, v47, v48
  v_max3_f32 v100, v100, v49, v50
  v_max3_f32 v100, v100, v51, v52
  v_max3_f32 v100, v100, v53, v54
  v_max3_f32 v100, v100, v55, v56
  v_max3_f32 v100, v100, v57, v58
  v_max3_f32 v104, v104, v100, v59
  s_barrier
  s_add_u32 s51, s51, 1
  s_cmp_lt_u32 s51, 16
  s_cbranch_scc1 L_att_fb_loop
  v_mov_b32 v100, v104
  v_mov_b32 v101, v104
  s_nop 1
  v_permlane32_swap_b32 v100, v101
  v_max_f32 v104, v100, v101
  s_lshl_b32 s44, s26, 8
  v_lshlrev_b32 v100, 2, v1
  v_add_u32 v101, s44, v100
  ds_write_b32 v101, v104
  s_waitcnt lgkmcnt(0)
  s_barrier
  v_xor_b32 v101, 1024, v101
  ds_read_b32 v102, v101
  s_waitcnt lgkmcnt(0)
  v_max_f32 v104, v104, v102
  v_add_f32 v100, 0x42b40000, v104
  v_sub_f32 v100, 0, v100
  v_cvt_pk_bf16_f32 v101, v100, v100
  v_lshlrev_b32 v101, 16, v101
  v_sub_f32 v102, v100, v101
  v_cvt_pk_bf16_f32 v101, v101, v102
  s_mov_b64 exec, s[42:43]
  v_mov_b32 v22, v101
  s_mov_b64 exec, -1
  s_barrier
  s_mov_b32 s49, s48
  s_add_u32 m0, s50, 0
  s_nop 0
  buffer_load_dwordx4 v4, s[16:19], s49 offen sc1 lds
  s_add_u32 m0, s50, 1024
  s_nop 0
  buffer_load_dwordx4 v5, s[16:19], s49 offen sc1 lds
  s_add_u32 s49, s49, 8192
  s_add_u32 m0, s50, 16384
  s_nop 0
  buffer_load_dwordx4 v4, s[16:19], s49 offen sc1 lds
  s_add_u32 m0, s50, 17408
  s_nop 0
  buffer_load_dwordx4 v5, s[16:19], s49 offen sc1 lds
  s_add_u32 s49, s49, 8192
  s_add_u32 m0, s50, 32768
  s_nop 0
  buffer_load_dwordx4 v4, s[16:19], s49 offen sc1 lds
  s_add_u32 m0, s50, 33792
  s_nop 0
  buffer_load_dwordx4 v5, s[16:19], s49 offen sc1 lds
  s_add_u32 s49, s49, 8192
  s_waitcnt vmcnt(0)
  s_barrier
  s_branch L_att_main
L_att_done:
  s_cmp_lt_u32 s37, 7
  s_cbranch_scc1 L_hasfin_41
  s_waitcnt vmcnt(0)
  s_barrier
  s_cmp_lg_u32 s26, 4
  s_cbranch_scc1 L_only_42
  s_lshl_b32 s44, s33, 7
  s_lshl_b32 s45, s32, 2
  s_add_u32 s44, s44, s45
  s_add_u32 s44, s44, 16785408
  v_mov_b32 v72, s61
  v_mov_b32 v73, 0
  s_mov_b64 exec, 1
  buffer_store_dword v72, v73, s[16:19], s44 offen sc1
  s_mov_b64 exec, -1
L_only_42:
  s_branch L_done
L_hasfin_41:
  s_lshl_b32 s47, s36, 1
  s_add_u32 s47, s47, s38
  s_mov_b32 s20, s80
  s_and_b32 s21, s81, 0xffff
  s_mov_b32 s22, 0x1c0000
  s_mov_b32 s23, 0x00020000
  s_mov_b32 s28, s78
  s_and_b32 s29, s79, 0xffff
  s_mov_b32 s30, 0x380
  s_mov_b32 s31, 0x00020000
  v_and_b32 v14, 15, v1
  v_lshlrev_b32 v14, 2, v14
  s_lshr_b32 s44, s36, 1
  s_lshl_b32 s44, s44, 7
  s_add_u32 s44, s44, 16785408
  v_add_u32 v14, s44, v14
  s_waitcnt vmcnt(28)
  s_barrier
  ds_read_b64_tr_b16 v[48:49], v10 offset:0
  ds_read_b64_tr_b16 v[50:51], v10 offset:4096
  ds_read_b64_tr_b16 v[52:53], v11 offset:0
  ds_read_b64_tr_b16 v[54:55], v11 offset:4096
  s_add_u32 m0, s58, 0
  s_add_u32 s59, s56, 172032
  buffer_load_dwordx4 v6, s[8:11], s59 offen lds
  ds_read_b64_tr_b16 v[56:57], v10 offset:1024
  ds_read_b64_tr_b16 v[58:59], v10 offset:5120
  ds_read_b64_tr_b16 v[60:61], v11 offset:1024
  ds_read_b64_tr_b16 v[62:63], v11 offset:5120
  s_waitcnt lgkmcnt(4)
  v_mfma_f32_32x32x16_bf16 v[16:31], v[48:51], v[144:147], 0
  buffer_load_dwordx4 v7, s[8:11], s59 offen offset:1024 lds
  v_mfma_f32_32x32x16_bf16 v[32:47], v[52:55], v[144:147], 0
  ds_read_b64_tr_b16 v[64:65], v10 offset:2048
  ds_read_b64_tr_b16 v[66:67], v10 offset:6144
  ds_read_b64_tr_b16 v[68:69], v11 offset:2048
  ds_read_b64_tr_b16 v[70:71], v11 offset:6144
  s_waitcnt vmcnt(29)
  s_waitcnt lgkmcnt(4)
  v_mfma_f32_32x32x16_bf16 v[16:31], v[56:59], v[148:151], v[16:31]
  buffer_load_dwordx4 v8, s[8:11], s59 offen offset:2048 lds
  v_mfma_f32_32x32x16_bf16 v[32:47], v[60:63], v[148:151], v[32:47]
  ds_read_b64_tr_b16 v[48:49], v10 offset:3072
  ds_read_b64_tr_b16 v[50:51], v10 offset:7168
  ds_read_b64_tr_b16 v[52:53], v11 offset:3072
  ds_read_b64_tr_b16 v[54:55], v11 offset:7168
  s_waitcnt vmcnt(29)
  s_waitcnt lgkmcnt(4)
  v_mfma_f32_32x32x16_bf16 v[16:31], v[64:67], v[152:155], v[16:31]
  buffer_load_dwordx4 v9, s[8:11], s59 offen offset:3072 lds
  v_mfma_f32_32x32x16_bf16 v[32:47], v[68:71], v[152:155], v[32:47]
  s_waitcnt lgkmcnt(0)
  s_barrier
  ds_read_b64_tr_b16 v[56:57], v10 offset:32768
  ds_read_b64_tr_b16 v[58:59], v10 offset:36864
  ds_read_b64_tr_b16 v[60:61], v11 offset:32768
  ds_read_b64_tr_b16 v[62:63], v11 offset:36864
  s_waitcnt vmcnt(29)
  v_mfma_f32_32x32x16_bf16 v[16:31], v[48:51], v[156:159], v[16:31]
  s_add_u32 m0, s58, 32768
  s_add_u32 s59, s56, 229376
  v_mfma_f32_32x32x16_bf16 v[32:47], v[52:55], v[156:159], v[32:47]
  buffer_load_dwordx4 v6, s[8:11], s59 offen lds
  ds_read_b64_tr_b16 v[64:65], v10 offset:33792
  ds_read_b64_tr_b16 v[66:67], v10 offset:37888
  ds_read_b64_tr_b16 v[68:69], v11 offset:33792
  ds_read_b64_tr_b16 v[70:71], v11 offset:37888
  s_waitcnt vmcnt(29)
  s_waitcnt lgkmcnt(4)
  v_mfma_f32_32x32x16_bf16 v[16:31], v[56:59], v[160:163], v[16:31]
  buffer_load_dwordx4 v7, s[8:11], s59 offen offset:1024 lds
  v_mfma_f32_32x32x16_bf16 v[32:47], v[60:63], v[160:163], v[32:47]
  ds_read_b64_tr_b16 v[48:49], v10 offset:34816
  ds_read_b64_tr_b16 v[50:51], v10 offset:38912
  ds_read_b64_tr_b16 v[52:53], v11 offset:34816
  ds_read_b64_tr_b16 v[54:55], v11 offset:38912
  s_waitcnt vmcnt(29)
  s_waitcnt lgkmcnt(4)
  v_mfma_f32_32x32x16_bf16 v[16:31], v[64:67], v[164:167], v[16:31]
  buffer_load_dwordx4 v8, s[8:11], s59 offen offset:2048 lds
  v_lshrrev_b32 v72, 3, v1
  v_mul_u32_u24 v140, 896, v72
  v_and_b32 v73, 7, v1
  v_lshlrev_b32 v73, 4, v73
  v_add_u32 v140, v140, v73
  s_lshl_b32 s60, s36, 3
  s_add_u32 s60, s60, s26
  v_mfma_f32_32x32x16_bf16 v[32:47], v[68:71], v[164:167], v[32:47]
  s_mul_i32 s60, s60, 7168
  s_lshl_b32 s45, s37, 7
  s_add_u32 s60, s60, s45
  buffer_load_dwordx4 v[132:135], v140, s[4:7], s60 offen
  buffer_load_dwordx4 v[136:139], v73, s[28:31], s45 offen
  v_and_b32 v141, 31, v1
  v_mul_u32_u24 v141, 272, v141
  ds_read_b64_tr_b16 v[56:57], v10 offset:35840
  ds_read_b64_tr_b16 v[58:59], v10 offset:39936
  ds_read_b64_tr_b16 v[60:61], v11 offset:35840
  ds_read_b64_tr_b16 v[62:63], v11 offset:39936
  s_waitcnt vmcnt(31)
  s_waitcnt lgkmcnt(4)
  v_mfma_f32_32x32x16_bf16 v[16:31], v[48:51], v[168:171], v[16:31]
  buffer_load_dwordx4 v9, s[8:11], s59 offen offset:3072 lds
  v_lshrrev_b32 v74, 5, v1
  v_lshlrev_b32 v74, 4, v74
  v_add_u32 v141, v141, v74
  s_mul_i32 s45, s39, 17408
  s_mul_i32 s46, s38, 8704
  s_add_u32 s45, s45, s46
  v_add_u32 v141, s45, v141
  v_mfma_f32_32x32x16_bf16 v[32:47], v[52:55], v[168:171], v[32:47]
  v_lshrrev_b32 v142, 3, v1
  s_lshl_b32 s45, s26, 3
  v_add_u32 v142, s45, v142
  v_mul_u32_u24 v142, 272, v142
  v_and_b32 v74, 7, v1
  v_lshlrev_b32 v74, 5, v74
  v_add_u32 v142, v142, v74
  s_waitcnt lgkmcnt(0)
  s_waitcnt vmcnt(10)
  s_barrier
  s_cmp_lg_u32 s26, 4
  s_cbranch_scc1 L_only_43
  s_lshl_b32 s44, s33, 7
  s_lshl_b32 s45, s32, 2
  s_add_u32 s44, s44, s45
  s_add_u32 s44, s44, 16785408
  v_mov_b32 v72, s61
  v_mov_b32 v73, 0
  s_mov_b64 exec, 1
  buffer_store_dword v72, v73, s[16:19], s44 offen sc1
  s_mov_b64 exec, -1
L_only_43:
  ds_read_b64_tr_b16 v[64:65], v12 offset:0
  ds_read_b64_tr_b16 v[66:67], v12 offset:4096
  ds_read_b64_tr_b16 v[68:69], v13 offset:0
  ds_read_b64_tr_b16 v[70:71], v13 offset:4096
  v_mfma_f32_32x32x16_bf16 v[16:31], v[56:59], v[172:175], v[16:31]
  s_add_u32 m0, s58, 65536
  s_add_u32 s59, s56, 286720
  v_mfma_f32_32x32x16_bf16 v[32:47], v[60:63], v[172:175], v[32:47]
  buffer_load_dwordx4 v6, s[8:11], s59 offen lds
  ds_read_b64_tr_b16 v[48:49], v12 offset:1024
  ds_read_b64_tr_b16 v[50:51], v12 offset:5120
  ds_read_b64_tr_b16 v[52:53], v13 offset:1024
  ds_read_b64_tr_b16 v[54:55], v13 offset:5120
  s_waitcnt lgkmcnt(4)
  v_mfma_f32_32x32x16_bf16 v[16:31], v[64:67], v[176:179], v[16:31]
  buffer_load_dwordx4 v7, s[8:11], s59 offen offset:1024 lds
  v_mfma_f32_32x32x16_bf16 v[32:47], v[68:71], v[176:179], v[32:47]
  ds_read_b64_tr_b16 v[56:57], v12 offset:2048
  ds_read_b64_tr_b16 v[58:59], v12 offset:6144
  ds_read_b64_tr_b16 v[60:61], v13 offset:2048
  ds_read_b64_tr_b16 v[62:63], v13 offset:6144
  s_waitcnt lgkmcnt(4)
  v_mfma_f32_32x32x16_bf16 v[16:31], v[48:51], v[180:183], v[16:31]
  buffer_load_dwordx4 v8, s[8:11], s59 offen offset:2048 lds
  v_mfma_f32_32x32x16_bf16 v[32:47], v[52:55], v[180:183], v[32:47]
  ds_read_b64_tr_b16 v[64:65], v12 offset:3072
  ds_read_b64_tr_b16 v[66:67], v12 offset:7168
  ds_read_b64_tr_b16 v[68:69], v13 offset:3072
  ds_read_b64_tr_b16 v[70:71], v13 offset:7168
  s_waitcnt lgkmcnt(4)
  v_mfma_f32_32x32x16_bf16 v[16:31], v[56:59], v[184:187], v[16:31]
  buffer_load_dwordx4 v9, s[8:11], s59 offen offset:3072 lds
  v_mfma_f32_32x32x16_bf16 v[32:47], v[60:63], v[184:187], v[32:47]
  s_waitcnt lgkmcnt(0)
  s_waitcnt vmcnt(10)
  s_barrier
  ds_read_b64_tr_b16 v[48:49], v2 offset:0
  ds_read_b64_tr_b16 v[50:51], v2 offset:4096
  ds_read_b64_tr_b16 v[52:53], v3 offset:0
  ds_read_b64_tr_b16 v[54:55], v3 offset:4096
  v_mfma_f32_32x32x16_bf16 v[16:31], v[64:67], v[188:191], v[16:31]
  s_add_u32 m0, s58, 98304
  s_add_u32 s59, s56, 344064
  v_mfma_f32_32x32x16_bf16 v[32:47], v[68:71], v[188:191], v[32:47]
  buffer_load_dwordx4 v6, s[8:11], s59 offen lds
  ds_read_b64_tr_b16 v[56:57], v2 offset:1024
  ds_read_b64_tr_b16 v[58:59], v2 offset:5120
  ds_read_b64_tr_b16 v[60:61], v3 offset:1024
  ds_read_b64_tr_b16 v[62:63], v3 offset:5120
  s_waitcnt lgkmcnt(4)
  v_mfma_f32_32x32x16_bf16 v[16:31], v[48:51], v[192:195], v[16:31]
  buffer_load_dwordx4 v7, s[8:11], s59 offen offset:1024 lds
  v_mfma_f32_32x32x16_bf16 v[32:47], v[52:55], v[192:195], v[32:47]
  ds_read_b64_tr_b16 v[64:65], v2 offset:2048
  ds_read_b64_tr_b16 v[66:67], v2 offset:6144
  ds_read_b64_tr_b16 v[68:69], v3 offset:2048
  ds_read_b64_tr_b16 v[70:71], v3 offset:6144
  s_waitcnt lgkmcnt(4)
  v_mfma_f32_32x32x16_bf16 v[16:31], v[56:59], v[196:199], v[16:31]
  buffer_load_dwordx4 v8, s[8:11], s59 offen offset:2048 lds
  v_mfma_f32_32x32x16_bf16 v[32:47], v[60:63], v[196:199], v[32:47]
  ds_read_b64_tr_b16 v[48:49], v2 offset:3072
  ds_read_b64_tr_b16 v[50:51], v2 offset:7168
  ds_read_b64_tr_b16 v[52:53], v3 offset:3072
  ds_read_b64_tr_b16 v[54:55], v3 offset:7168
  s_waitcnt lgkmcnt(4)
  v_mfma_f32_32x32x16_bf16 v[16:31], v[64:67], v[200:203], v[16:31]
  buffer_load_dwordx4 v9, s[8:11], s59 offen offset:3072 lds
  v_mfma_f32_32x32x16_bf16 v[32:47], v[68:71], v[200:203], v[32:47]
  s_waitcnt lgkmcnt(0)
  s_waitcnt vmcnt(8)
  s_barrier
  buffer_load_dword v15, v14, s[16:19], 0 offen sc1
  ds_read_b64_tr_b16 v[56:57], v2 offset:32768
  ds_read_b64_tr_b16 v[58:59], v2 offset:36864
  ds_read_b64_tr_b16 v[60:61], v3 offset:32768
  ds_read_b64_tr_b16 v[62:63], v3 offset:36864
  v_mfma_f32_32x32x16_bf16 v[16:31], v[48:51], v[204:207], v[16:31]
  v_subrev_u32 v8, 3584, v8
  v_subrev_u32 v9, 3584, v9
  s_add_u32 m0, s58, 131072
  v_mfma_f32_32x32x16_bf16 v[32:47], v[52:55], v[204:207], v[32:47]
  s_add_u32 s59, s57, 0
  buffer_load_dwordx4 v6, s[12:15], s59 offen lds
  ds_read_b64_tr_b16 v[64:65], v2 offset:33792
  ds_read_b64_tr_b16 v[66:67], v2 offset:37888
  ds_read_b64_tr_b16 v[68:69], v3 offset:33792
  ds_read_b64_tr_b16 v[70:71], v3 offset:37888
  s_waitcnt lgkmcnt(4)
  v_mfma_f32_32x32x16_bf16 v[16:31], v[56:59], v[208:211], v[16:31]
  buffer_load_dwordx4 v7, s[12:15], s59 offen offset:1024 lds
  v_mfma_f32_32x32x16_bf16 v[32:47], v[60:63], v[208:211], v[32:47]
  ds_read_b64_tr_b16 v[48:49], v2 offset:34816
  ds_read_b64_tr_b16 v[50:51], v2 offset:38912
  ds_read_b64_tr_b16 v[52:53], v3 offset:34816
  ds_read_b64_tr_b16 v[54:55], v3 offset:38912
  s_waitcnt lgkmcnt(4)
  v_mfma_f32_32x32x16_bf16 v[16:31], v[64:67], v[212:215], v[16:31]
  buffer_load_dwordx4 v8, s[12:15], s59 offen offset:2048 lds
  v_mfma_f32_32x32x16_bf16 v[32:47], v[68:71], v[212:215], v[32:47]
  ds_read_b64_tr_b16 v[56:57], v2 offset:35840
  ds_read_b64_tr_b16 v[58:59], v2 offset:39936
  ds_read_b64_tr_b16 v[60:61], v3 offset:35840
  ds_read_b64_tr_b16 v[62:63], v3 offset:39936
  s_waitcnt lgkmcnt(4)
  v_mfma_f32_32x32x16_bf16 v[16:31], v[48:51], v[216:219], v[16:31]
  buffer_load_dwordx4 v9, s[12:15], s59 offen offset:3072 lds
  v_mfma_f32_32x32x16_bf16 v[32:47], v[52:55], v[216:219], v[32:47]
  s_waitcnt lgkmcnt(0)
  s_waitcnt vmcnt(9)
  s_cmp_lg_u32 s26, 4
  s_cbranch_scc1 L_only_44
  s_waitcnt vmcnt(4)
  v_cmp_ne_u32 vcc, s61, v15
  s_nop 0
  s_cbranch_vccz L_opd_45
  s_mov_b32 s62, 0x10000
L_poll_o_46:
  buffer_load_dword v15, v14, s[16:19], 0 offen sc1
  s_waitcnt vmcnt(0)
  v_cmp_ne_u32 vcc, s61, v15
  s_nop 0
  s_cbranch_vccz L_polld_o_47
  s_sub_u32 s62, s62, 1
  s_cmp_eq_u32 s62, 0
  s_cbranch_scc1 L_polld_o_47
  s_sleep 1
  s_branch L_poll_o_46
L_polld_o_47:
L_opd_45:
L_only_44:
  s_barrier
  ds_read_b64_tr_b16 v[64:65], v10 offset:0
  ds_read_b64_tr_b16 v[66:67], v10 offset:4096
  ds_read_b64_tr_b16 v[68:69], v11 offset:0
  ds_read_b64_tr_b16 v[70:71], v11 offset:4096
  v_mfma_f32_32x32x16_bf16 v[16:31], v[56:59], v[220:223], v[16:31]
  s_add_u32 m0, s58, 0
  s_add_u32 s59, s57, 50176
  buffer_load_dwordx4 v6, s[12:15], s59 offen lds
  s_lshl_b32 s45, s47, 4
  s_lshl_b32 s46, s39, 2
  v_mfma_f32_32x32x16_bf16 v[32:47], v[60:63], v[220:223], v[32:47]
  s_add_u32 s45, s45, s46
  s_lshl_b32 s45, s45, 11
  s_add_u32 s45, s45, 14680064
  buffer_load_dwordx4 v[100:103], v4, s[16:19], s45 offen offset:0 sc1
  ds_read_b64_tr_b16 v[48:49], v10 offset:1024
  ds_read_b64_tr_b16 v[50:51], v10 offset:5120
  ds_read_b64_tr_b16 v[52:53], v11 offset:1024
  ds_read_b64_tr_b16 v[54:55], v11 offset:5120
  s_waitcnt lgkmcnt(4)
  v_mfma_f32_32x32x16_bf16 v[16:31], v[64:67], v[224:227], v[16:31]
  buffer_load_dwordx4 v7, s[12:15], s59 offen offset:1024 lds
  v_mfma_f32_32x32x16_bf16 v[32:47], v[68:71], v[224:227], v[32:47]
  buffer_load_dwordx4 v[104:107], v4, s[16:19], s45 offen offset:1024 sc1
  ds_read_b64_tr_b16 v[56:57], v10 offset:2048
  ds_read_b64_tr_b16 v[58:59], v10 offset:6144
  ds_read_b64_tr_b16 v[60:61], v11 offset:2048
  ds_read_b64_tr_b16 v[62:63], v11 offset:6144
  s_waitcnt lgkmcnt(4)
  v_mfma_f32_32x32x16_bf16 v[16:31], v[48:51], v[228:231], v[16:31]
  buffer_load_dwordx4 v8, s[12:15], s59 offen offset:2048 lds
  v_mfma_f32_32x32x16_bf16 v[32:47], v[52:55], v[228:231], v[32:47]
  buffer_load_dwordx4 v[108:111], v4, s[16:19], s45 offen offset:2048 sc1
  ds_read_b64_tr_b16 v[64:65], v10 offset:3072
  ds_read_b64_tr_b16 v[66:67], v10 offset:7168
  ds_read_b64_tr_b16 v[68:69], v11 offset:3072
  ds_read_b64_tr_b16 v[70:71], v11 offset:7168
  s_waitcnt lgkmcnt(4)
  v_mfma_f32_32x32x16_bf16 v[16:31], v[56:59], v[232:235], v[16:31]
  buffer_load_dwordx4 v9, s[12:15], s59 offen offset:3072 lds
  v_mfma_f32_32x32x16_bf16 v[32:47], v[60:63], v[232:235], v[32:47]
  buffer_load_dwordx4 v[112:115], v4, s[16:19], s45 offen offset:3072 sc1
  s_waitcnt lgkmcnt(0)
  s_waitcnt vmcnt(13)
  s_barrier
  ds_read_b64_tr_b16 v[48:49], v10 offset:32768
  ds_read_b64_tr_b16 v[50:51], v10 offset:36864
  ds_read_b64_tr_b16 v[52:53], v11 offset:32768
  ds_read_b64_tr_b16 v[54:55], v11 offset:36864
  v_mfma_f32_32x32x16_bf16 v[16:31], v[64:67], v[236:239], v[16:31]
  s_add_u32 s45, s45, 4096
  v_mfma_f32_32x32x16_bf16 v[32:47], v[68:71], v[236:239], v[32:47]
  buffer_load_dwordx4 v[116:119], v4, s[16:19], s45 offen offset:0 sc1
  ds_read_b64_tr_b16 v[56:57], v10 offset:33792
  ds_read_b64_tr_b16 v[58:59], v10 offset:37888
  ds_read_b64_tr_b16 v[60:61], v11 offset:33792
  ds_read_b64_tr_b16 v[62:63], v11 offset:37888
  s_waitcnt lgkmcnt(4)
  v_mfma_f32_32x32x16_bf16 v[16:31], v[48:51], v[240:243], v[16:31]
  buffer_load_dwordx4 v[120:123], v4, s[16:19], s45 offen offset:1024 sc1
  v_lshlrev_b32 v74, 16, v132
  v_and_b32 v75, s41, v132
  v_lshlrev_b32 v76, 16, v133
  v_and_b32 v77, s41, v133
  v_lshlrev_b32 v78, 16, v134
  v_mfma_f32_32x32x16_bf16 v[32:47], v[52:55], v[240:243], v[32:47]
  v_and_b32 v79, s41, v134
  v_lshlrev_b32 v80, 16, v135
  v_and_b32 v81, s41, v135
  v_lshlrev_b32 v132, 16, v136
  v_and_b32 v133, s41, v136
  v_add_f32 v74, v74, v132
  v_add_f32 v75, v75, v133
  ds_read_b64_tr_b16 v[64:65], v10 offset:34816
  ds_read_b64_tr_b16 v[66:67], v10 offset:38912
  ds_read_b64_tr_b16 v[68:69], v11 offset:34816
  ds_read_b64_tr_b16 v[70:71], v11 offset:38912
  s_waitcnt lgkmcnt(4)
  v_mfma_f32_32x32x16_bf16 v[16:31], v[56:59], v[244:247], v[16:31]
  buffer_load_dwordx4 v[124:127], v4, s[16:19], s45 offen offset:2048 sc1
  v_lshlrev_b32 v132, 16, v137
  v_and_b32 v133, s41, v137
  v_add_f32 v76, v76, v132
  v_add_f32 v77, v77, v133
  v_lshlrev_b32 v132, 16, v138
  v_and_b32 v133, s41, v138
  v_mfma_f32_32x32x16_bf16 v[32:47], v[60:63], v[244:247], v[32:47]
  v_add_f32 v78, v78, v132
  v_add_f32 v79, v79, v133
  v_lshlrev_b32 v132, 16, v139
  v_and_b32 v133, s41, v139
  v_add_f32 v80, v80, v132
  v_add_f32 v81, v81, v133
  ds_read_b64_tr_b16 v[48:49], v10 offset:35840
  ds_read_b64_tr_b16 v[50:51], v10 offset:39936
  ds_read_b64_tr_b16 v[52:53], v11 offset:35840
  ds_read_b64_tr_b16 v[54:55], v11 offset:39936
  s_waitcnt lgkmcnt(4)
  v_mfma_f32_32x32x16_bf16 v[16:31], v[64:67], v[248:251], v[16:31]
  buffer_load_dwordx4 v[128:131], v4, s[16:19], s45 offen offset:3072 sc1
  v_mfma_f32_32x32x16_bf16 v[32:47], v[68:71], v[248:251], v[32:47]
  s_waitcnt lgkmcnt(0)
  s_waitcnt vmcnt(12)
  s_barrier
  ds_read_b64_tr_b16 v[56:57], v12 offset:0
  ds_read_b64_tr_b16 v[58:59], v12 offset:4096
  ds_read_b64_tr_b16 v[60:61], v13 offset:0
  ds_read_b64_tr_b16 v[62:63], v13 offset:4096
  v_mfma_f32_32x32x16_bf16 v[16:31], v[48:51], v[252:255], v[16:31]
  v_mfma_f32_32x32x16_bf16 v[32:47], v[52:55], v[252:255], v[32:47]
  ds_read_b64_tr_b16 v[64:65], v12 offset:1024
  ds_read_b64_tr_b16 v[66:67], v12 offset:5120
  ds_read_b64_tr_b16 v[68:69], v13 offset:1024
  ds_read_b64_tr_b16 v[70:71], v13 offset:5120
  s_waitcnt vmcnt(10)
  s_waitcnt lgkmcnt(4)
  v_mfma_f32_32x32x16_bf16 v[16:31], v[56:59], v[100:103], v[16:31]
  v_mfma_f32_32x32x16_bf16 v[32:47], v[60:63], v[100:103], v[32:47]
  ds_read_b64_tr_b16 v[48:49], v12 offset:2048
  ds_read_b64_tr_b16 v[50:51], v12 offset:6144
  ds_read_b64_tr_b16 v[52:53], v13 offset:2048
  ds_read_b64_tr_b16 v[54:55], v13 offset:6144
  s_waitcnt vmcnt(8)
  s_waitcnt lgkmcnt(4)
  v_mfma_f32_32x32x16_bf16 v[16:31], v[64:67], v[104:107], v[16:31]
  v_mfma_f32_32x32x16_bf16 v[32:47], v[68:71], v[104:107], v[32:47]
  ds_read_b64_tr_b16 v[56:57], v12 offset:3072
  ds_read_b64_tr_b16 v[58:59], v12 offset:7168
  ds_read_b64_tr_b16 v[60:61], v13 offset:3072
  ds_read_b64_tr_b16 v[62:63], v13 offset:7168
  s_waitcnt vmcnt(6)
  s_waitcnt lgkmcnt(4)
  v_mfma_f32_32x32x16_bf16 v[16:31], v[48:51], v[108:111], v[16:31]
  v_mfma_f32_32x32x16_bf16 v[32:47], v[52:55], v[108:111], v[32:47]
  s_waitcnt lgkmcnt(0)
  s_waitcnt vmcnt(5)
  s_barrier
  ds_read_b64_tr_b16 v[64:65], v2 offset:0
  ds_read_b64_tr_b16 v[66:67], v2 offset:4096
  ds_read_b64_tr_b16 v[68:69], v3 offset:0
  ds_read_b64_tr_b16 v[70:71], v3 offset:4096
  s_waitcnt vmcnt(4)
  v_mfma_f32_32x32x16_bf16 v[16:31], v[56:59], v[112:115], v[16:31]
  v_mfma_f32_32x32x16_bf16 v[32:47], v[60:63], v[112:115], v[32:47]
  ds_read_b64_tr_b16 v[48:49], v2 offset:1024
  ds_read_b64_tr_b16 v[50:51], v2 offset:5120
  ds_read_b64_tr_b16 v[52:53], v3 offset:1024
  ds_read_b64_tr_b16 v[54:55], v3 offset:5120
  s_waitcnt vmcnt(3)
  s_waitcnt lgkmcnt(4)
  v_mfma_f32_32x32x16_bf16 v[16:31], v[64:67], v[116:119], v[16:31]
  v_mfma_f32_32x32x16_bf16 v[32:47], v[68:71], v[116:119], v[32:47]
  ds_read_b64_tr_b16 v[56:57], v2 offset:2048
  ds_read_b64_tr_b16 v[58:59], v2 offset:6144
  ds_read_b64_tr_b16 v[60:61], v3 offset:2048
  ds_read_b64_tr_b16 v[62:63], v3 offset:6144
  s_waitcnt vmcnt(2)
  s_waitcnt lgkmcnt(4)
  v_mfma_f32_32x32x16_bf16 v[16:31], v[48:51], v[120:123], v[16:31]
  v_mfma_f32_32x32x16_bf16 v[32:47], v[52:55], v[120:123], v[32:47]
  ds_read_b64_tr_b16 v[64:65], v2 offset:3072
  ds_read_b64_tr_b16 v[66:67], v2 offset:7168
  ds_read_b64_tr_b16 v[68:69], v3 offset:3072
  ds_read_b64_tr_b16 v[70:71], v3 offset:7168
  s_waitcnt vmcnt(1)
  s_waitcnt lgkmcnt(4)
  v_mfma_f32_32x32x16_bf16 v[16:31], v[56:59], v[124:127], v[16:31]
  v_mfma_f32_32x32x16_bf16 v[32:47], v[60:63], v[124:127], v[32:47]
  s_waitcnt lgkmcnt(0)
  s_waitcnt vmcnt(0)
  v_mfma_f32_32x32x16_bf16 v[16:31], v[64:67], v[128:131], v[16:31]
  v_mfma_f32_32x32x16_bf16 v[32:47], v[68:71], v[128:131], v[32:47]
  s_barrier
  s_nop 7
  s_nop 1
  ds_write_b128 v141, v[16:19] offset:0
  ds_write_b128 v141, v[20:23] offset:32
  ds_write_b128 v141, v[24:27] offset:64
  ds_write_b128 v141, v[28:31] offset:96
  ds_write_b128 v141, v[32:35] offset:128
  ds_write_b128 v141, v[36:39] offset:160
  ds_write_b128 v141, v[40:43] offset:192
  ds_write_b128 v141, v[44:47] offset:224
  s_waitcnt lgkmcnt(0)
  s_barrier
  ds_read_b128 v[16:19], v142 offset:0
  ds_read_b128 v[20:23], v142 offset:16
  ds_read_b128 v[24:27], v142 offset:17408
  ds_read_b128 v[28:31], v142 offset:17424
  ds_read_b128 v[32:35], v142 offset:34816
  ds_read_b128 v[36:39], v142 offset:34832
  ds_read_b128 v[40:43], v142 offset:52224
  ds_read_b128 v[44:47], v142 offset:52240
  s_waitcnt lgkmcnt(4)
  v_add_f32 v16, v16, v24
  v_add_f32 v17, v17, v25
  v_add_f32 v18, v18, v26
  v_add_f32 v19, v19, v27
  v_add_f32 v20, v20, v28
  v_add_f32 v21, v21, v29
  v_add_f32 v22, v22, v30
  v_add_f32 v23, v23, v31
  v_add_f32 v16, v16, v74
  v_add_f32 v17, v17, v75
  v_add_f32 v18, v18, v76
  v_add_f32 v19, v19, v77
  v_add_f32 v20, v20, v78
  v_add_f32 v21, v21, v79
  v_add_f32 v22, v22, v80
  v_add_f32 v23, v23, v81
  s_waitcnt lgkmcnt(0)
  v_add_f32 v32, v32, v40
  v_add_f32 v33, v33, v41
  v_add_f32 v34, v34, v42
  v_add_f32 v35, v35, v43
  v_add_f32 v36, v36, v44
  v_add_f32 v37, v37, v45
  v_add_f32 v38, v38, v46
  v_add_f32 v39, v39, v47
  v_add_f32 v16, v16, v32
  v_add_f32 v17, v17, v33
  v_add_f32 v18, v18, v34
  v_add_f32 v19, v19, v35
  v_add_f32 v20, v20, v36
  v_add_f32 v21, v21, v37
  v_add_f32 v22, v22, v38
  v_add_f32 v23, v23, v39
  v_cvt_pk_bf16_f32 v24, v16, v17
  v_cvt_pk_bf16_f32 v25, v18, v19
  v_cvt_pk_bf16_f32 v26, v20, v21
  v_cvt_pk_bf16_f32 v27, v22, v23
  buffer_store_dwordx4 v[24:27], v140, s[20:23], s60 offen
L_done:
  s_waitcnt vmcnt(0)
  s_waitcnt vmcnt(0)
L_end:
  s_endpgm
.section .rodata,"a"
.p2align 6
.amdhsa_kernel parallel_sum__softmax_full_mha__dense_activation_squared_relu__prompt_kernel
  .amdhsa_next_free_vgpr 256
  .amdhsa_next_free_sgpr 102
  .amdhsa_accum_offset 256
  .amdhsa_group_segment_fixed_size 0
  .amdhsa_kernarg_size 88
  .amdhsa_user_sgpr_count 2
  .amdhsa_user_sgpr_kernarg_segment_ptr 1
  .amdhsa_system_sgpr_workgroup_id_x 1
  .amdhsa_float_denorm_mode_32 3
.end_amdhsa_kernel
```
